```python
import torch

def _softmax(x, axis=-1):
    return torch.softmax(x, dim=axis)
def _gelu(x):
    return torch.nn.functional.gelu(x, approximate="tanh")
def _silu(x):
    return torch.nn.functional.silu(x)
def _sigmoid(x):
    return torch.sigmoid(x)
def _layernorm(x, axis=-1, eps=1e-5):
    m = x.mean(dim=axis, keepdim=True)
    v = x.var(dim=axis, keepdim=True, unbiased=False)
    return (x - m) / torch.sqrt(v + eps)
def _scatter_add(tgt, idx, src, axis=0):
    return tgt.clone().index_add_(axis, idx, src)
def _segment_sum(src, seg, n):
    out = torch.zeros((n,) + src.shape[1:], dtype=src.dtype)
    return out.index_add_(0, seg, src)
def _pad(x, pw):
    flat = tuple(v for pair in reversed(pw) for v in pair)
    return torch.nn.functional.pad(x, flat)

kernel_name = 'standalone__detection_seg_mask2former__vision'

def setup_inputs():

    _w = (lambda a: (lambda t: t.to(torch.bfloat16) if t.is_floating_point() else t)(torch.as_tensor(a)))
    H = W = 384
    C = 96
    Hc, Wc = H // 2, W // 2
    nh = 4
    Nq = 16
    sc = C ** -0.5
    return {
        "q": _w((lambda *s: torch.randn(*s, dtype=torch.bfloat16) * 0.2)(1, Nq, C)),
        "f_hi": _w((lambda *s: torch.randn(*s, dtype=torch.bfloat16) * 0.2)(1, H, W, C)),
        "f_lo": _w((lambda *s: torch.randn(*s, dtype=torch.bfloat16) * 0.4)(1, Hc, Wc, C)),
        "w_lat": _w((lambda *s: torch.randn(*s, dtype=torch.bfloat16) * 0.4)(C, C) * sc),
        "w_q": _w((lambda *s: torch.randn(*s, dtype=torch.bfloat16) * 3.2)(nh, C, C // nh) * sc),
        "w_k": _w((lambda *s: torch.randn(*s, dtype=torch.bfloat16) * 3.2)(nh, C, C // nh) * sc),
        "w_v": _w((lambda *s: torch.randn(*s, dtype=torch.bfloat16) * 3.2)(nh, C, C // nh) * sc),
        "w_o": _w((lambda *s: torch.randn(*s, dtype=torch.bfloat16) * 3.2)(C, C) * sc),
        "w_m": _w((lambda *s: torch.randn(*s, dtype=torch.bfloat16) * 1.6)(C, C) * sc),
    }

def reference(q, f_hi, f_lo, w_lat, w_q, w_k, w_v, w_o, w_m):
    B, Nq, C = q.shape
    _, H, W, _ = f_hi.shape
    nh = w_q.shape[0]
    dh = C // nh
    up = (lambda x, n, axis: torch.repeat_interleave(x, n, dim=axis))((lambda x, n, axis: torch.repeat_interleave(x, n, dim=axis))(f_lo, 2, axis=1), 2, axis=2)
    feat = f_hi + up @ w_lat
    feat = _layernorm(feat, axis=-1)
    kv = feat.reshape(B, H * W, C)
    m_embed = q @ w_m
    mask_bias = torch.einsum('bqc,bkc->bqk', m_embed, kv) * (C ** -0.5)
    Q = torch.einsum('bqc,hcd->bhqd', q, w_q)
    K = torch.einsum('bkc,hcd->bhkd', kv, w_k)
    V = torch.einsum('bkc,hcd->bhkd', kv, w_v)
    logits = torch.einsum('bhqd,bhkd->bhqk', Q, K) * (dh ** -0.5)
    logits = logits + mask_bias[:, None, :, :]
    attn = _softmax(logits, axis=-1)
    ctx = torch.einsum('bhqk,bhkd->bqhd', attn, V).reshape(B, Nq, C)
    return q + ctx @ w_o
```

```asm
; @launch grid=(256,1,1) block=(768,1,1) lds=163840
.amdgcn_target "amdgcn-amd-amdhsa--gfx950"
.text
.globl standalone__detection_seg_mask2former__vision_kernel
.p2align 8
.type standalone__detection_seg_mask2former__vision_kernel,@function
standalone__detection_seg_mask2former__vision_kernel:
s_load_dwordx16 s[16:31], s[0:1], 0
s_load_dwordx8 s[32:39], s[0:1], 64
s_cmp_ge_u32 s2, 256
s_cbranch_scc1 L_exit
v_lshrrev_b32 v2, 6, v0
v_and_b32 v1, 63, v0
v_readfirstlane_b32 s3, v2
s_mov_b32 s15, 500000
s_mov_b32 s8, 73728
s_mov_b32 s9, 0xffff0000
s_cmp_ge_u32 s3, 8
s_cbranch_scc1 L_att
v_lshlrev_b32 v5, 4, v1
s_mul_i32 s58, s2, 9
s_add_u32 s52, s58, s3
s_add_u32 s53, s58, 8
s_mul_i32 s55, s3, 3072
s_add_u32 s55, s55, 49152
s_mul_i32 s6, s3, 6144
s_mov_b32 s42, 18432
s_mov_b32 s43, 0x20000
s_mov_b32 s46, 7077888
s_mov_b32 s47, 0x20000
s_and_b32 s57, s3, 1
s_lshr_b32 s58, s3, 1
s_mul_i32 s59, s57, 9224
s_mul_i32 s57, s57, 1536
s_mul_i32 s7, s58, 3072
s_add_u32 s59, s59, s7
s_add_u32 m0, s59, 73728
s_lshl_b32 s7, s7, 1
s_add_u32 s57, s57, s7
v_and_b32 v6, 32, v1
v_mad_u32_u24 v6, v6, 48, v5
s_cmp_ge_u32 s3, 6
s_waitcnt lgkmcnt(0)
s_mov_b32 s40, s22
s_mov_b32 s41, s23
s_cbranch_scc1 L_1
buffer_load_dwordx4 v5, s[40:43], s57 offen lds
buffer_load_dwordx4 v6, s[40:43], s57 offen offset:1024 lds
s_add_u32 s57, s57, 1536
buffer_load_dwordx4 v5, s[40:43], s57 offen offset:2048 lds
L_1:
s_mov_b32 s44, s20
s_mov_b32 s45, s21
s_cmp_ge_u32 s3, 4
s_cbranch_scc1 L_2
s_mul_i32 s57, s52, 3072
s_mov_b32 m0, s55
s_nop 0
buffer_load_dwordx4 v5, s[44:47], s57 offen offset:0 nt lds
buffer_load_dwordx4 v5, s[44:47], s57 offen offset:1024 nt lds
buffer_load_dwordx4 v5, s[44:47], s57 offen offset:2048 nt lds
L_2:
s_mov_b32 s40, s18
s_mov_b32 s41, s19
s_mov_b32 s42, 28311552
s_mov_b32 s43, 0x20000
v_lshrrev_b32 v15, 4, v1
v_and_b32 v22, 15, v1
s_add_u32 s12, s38, 1179648
s_addc_u32 s13, s39, 0
s_load_dword s14, s[12:13], 0
v_mov_b32 v4, 156688
v_mov_b32 v7, 1
v_and_b32 v8, 3, v1
v_and_b32 v6, 1, v15
v_mul_u32_u24 v23, 9224, v6
v_lshrrev_b32 v6, 1, v15
v_mul_u32_u24 v6, 1536, v6
v_add3_u32 v23, v23, v6, s8
v_lshrrev_b32 v6, 2, v22
v_mul_u32_u24 v6, 192, v6
v_lshl_add_u32 v6, v8, 4, v6
v_add_u32 v23, v23, v6
s_barrier
s_cmp_lt_u32 s3, 4
s_cbranch_scc1 L_3
s_mul_i32 s57, s52, 3072
s_mov_b32 m0, s55
s_nop 0
buffer_load_dwordx4 v5, s[44:47], s57 offen offset:0 nt lds
buffer_load_dwordx4 v5, s[44:47], s57 offen offset:1024 nt lds
buffer_load_dwordx4 v5, s[44:47], s57 offen offset:2048 nt lds
L_3:
s_cmp_lt_u32 s3, 6
s_cbranch_scc1 L_4
s_sub_u32 s59, s3, 6
s_mul_i32 s59, s59, 1536
s_mul_i32 s57, s53, 3072
s_add_u32 s57, s57, s59
s_add_u32 m0, s59, 160016
s_nop 0
buffer_load_dwordx4 v5, s[44:47], s57 offen nt lds
s_mov_b32 exec_hi, 0
buffer_load_dwordx4 v5, s[44:47], s57 offen offset:1024 nt lds
s_mov_b32 exec_hi, -1
L_4:
s_setprio 2
v_cmp_le_u32 vcc, 48, v1
s_nop 1
v_cndmask_b32 v6, 0, 16, vcc
v_xor_b32 v12, v6, v5
v_xor_b32 v18, 64, v12
v_cmp_le_u32 vcc, 32, v1
s_nop 1
v_cndmask_b32 v6, 16, 32, vcc
v_xor_b32 v13, v6, v5
v_xor_b32 v19, 64, v13
v_cmp_le_u32 vcc, 16, v1
s_nop 1
v_cndmask_b32 v6, 32, 48, vcc
v_xor_b32 v14, v6, v5
v_xor_b32 v20, 64, v14
v_mul_u32_u24 v9, 192, v22
v_lshl_add_u32 v9, v15, 4, v9
v_add_u32 v166, s55, v9
v_add_u32 v8, 160016, v9
s_mul_hi_u32 s57, s52, 0x15555556
s_mul_i32 s58, s57, 12
s_sub_u32 s58, s52, s58
s_mul_i32 s57, s57, 147456
s_mul_i32 s58, s58, 6144
s_add_u32 s54, s57, s58
s_and_b32 s57, s3, 4
s_lshl_b32 s57, s57, 1
s_and_b32 s58, s3, 2
s_add_u32 s57, s57, s58
v_lshl_add_u32 v3, s57, 1, v4
v_lshrrev_b32 v6, 1, v15
v_lshlrev_b32 v6, 1, v6
v_lshl_add_u32 v6, v15, 2, v6
v_xor_b32 v6, v6, v22
v_lshl_add_u32 v6, v15, 4, v6
v_lshl_add_u32 v2, v6, 4, s6
v_lshrrev_b32 v6, 1, v22
v_xor_b32 v6, v6, v15
v_lshl_add_u32 v6, v6, 4, s6
v_mul_u32_u24 v16, 384, v22
v_add_u32 v16, v16, v6
v_xor_b32 v17, 64, v16
v_lshrrev_b32 v6, 2, v22
v_cmp_eq_u32 vcc, v6, v15
v_and_b32 v6, 1, v1
v_lshlrev_b32 v6, 4, v6
v_mov_b32 v24, 0x3f80
v_lshlrev_b32 v6, v6, v24
v_cndmask_b32 v6, 0, v6, vcc
v_bfe_u32 v24, v1, 1, 1
v_cmp_eq_u32 vcc, 0, v24
s_nop 1
v_cndmask_b32 v26, 0, v6, vcc
v_cndmask_b32 v27, v6, 0, vcc
v_mov_b32 v24, 0
v_mov_b32 v25, 0
v_mov_b32 v28, 0
v_mov_b32 v29, 0
v_mov_b32 v30, 1.0
v_mov_b32 v31, 0x3727c5ac
v_mov_b32 v0, 0x3c2aaaab
s_cmp_ge_u32 s3, 6
s_cbranch_scc1 L_5
s_waitcnt vmcnt(3)
s_mov_b64 exec, 1
ds_add_u32 v4, v7 offset:84
s_mov_b64 exec, -1
L_5:
Lpoll_6:
ds_read_b32 v6, v4 offset:84
s_waitcnt lgkmcnt(0)
v_readfirstlane_b32 s57, v6
s_sub_u32 s15, s15, 1
s_cselect_b32 s57, 6, s57
s_cmp_lt_u32 s57, 6
s_cbranch_scc1 Lpoll_6
ds_read_b64_tr_b16 v[32:33], v23 offset:0
ds_read_b64_tr_b16 v[34:35], v23 offset:768
ds_read_b64_tr_b16 v[44:45], v23 offset:8
ds_read_b64_tr_b16 v[46:47], v23 offset:776
ds_read_b64_tr_b16 v[56:57], v23 offset:64
ds_read_b64_tr_b16 v[58:59], v23 offset:832
ds_read_b64_tr_b16 v[68:69], v23 offset:72
ds_read_b64_tr_b16 v[70:71], v23 offset:840
ds_read_b64_tr_b16 v[80:81], v23 offset:128
ds_read_b64_tr_b16 v[82:83], v23 offset:896
ds_read_b64_tr_b16 v[92:93], v23 offset:136
ds_read_b64_tr_b16 v[94:95], v23 offset:904
s_waitcnt vmcnt(0)
ds_read_b128 v[128:131], v166 offset:0
ds_read_b128 v[132:135], v166 offset:64
ds_read_b128 v[136:139], v166 offset:128
s_cmp_lt_u32 s3, 6
s_cbranch_scc1 L_9
s_mov_b64 exec, 1
ds_add_u32 v4, v7 offset:132
s_mov_b64 exec, -1
L_9:
s_cmp_ge_u32 s3, 4
s_cbranch_scc1 L_10
s_add_u32 m0, s6, 0
s_add_u32 s57, s54, 0
buffer_load_dwordx4 v12, s[40:43], s57 offen offset:0 nt lds
buffer_load_dwordx4 v13, s[40:43], s57 offen offset:1024 nt lds
buffer_load_dwordx4 v14, s[40:43], s57 offen offset:2048 nt lds
s_add_u32 m0, s6, 3072
s_add_u32 s57, s54, 3072
buffer_load_dwordx4 v18, s[40:43], s57 offen offset:0 nt lds
buffer_load_dwordx4 v19, s[40:43], s57 offen offset:1024 nt lds
buffer_load_dwordx4 v20, s[40:43], s57 offen offset:2048 nt lds
L_10:
s_waitcnt lgkmcnt(13)
s_waitcnt lgkmcnt(2)
v_mfma_f32_16x16x32_bf16 v[104:107], v[32:35], v[128:131], 0
ds_read_b64_tr_b16 v[36:37], v23 offset:3072
ds_read_b64_tr_b16 v[38:39], v23 offset:3840
v_mfma_f32_16x16x32_bf16 v[108:111], v[44:47], v[128:131], 0
ds_read_b64_tr_b16 v[48:49], v23 offset:3080
ds_read_b64_tr_b16 v[50:51], v23 offset:3848
v_mfma_f32_16x16x32_bf16 v[112:115], v[56:59], v[128:131], 0
ds_read_b64_tr_b16 v[60:61], v23 offset:3136
ds_read_b64_tr_b16 v[62:63], v23 offset:3904
v_mfma_f32_16x16x32_bf16 v[116:119], v[68:71], v[128:131], 0
ds_read_b64_tr_b16 v[72:73], v23 offset:3144
ds_read_b64_tr_b16 v[74:75], v23 offset:3912
v_mfma_f32_16x16x32_bf16 v[120:123], v[80:83], v[128:131], 0
ds_read_b64_tr_b16 v[84:85], v23 offset:3200
ds_read_b64_tr_b16 v[86:87], v23 offset:3968
v_mfma_f32_16x16x32_bf16 v[124:127], v[92:95], v[128:131], 0
ds_read_b64_tr_b16 v[96:97], v23 offset:3208
ds_read_b64_tr_b16 v[98:99], v23 offset:3976
s_waitcnt lgkmcnt(10)
v_mfma_f32_16x16x32_bf16 v[104:107], v[36:39], v[132:135], v[104:107]
ds_read_b64_tr_b16 v[40:41], v23 offset:6144
ds_read_b64_tr_b16 v[42:43], v23 offset:6912
s_waitcnt lgkmcnt(10)
v_mfma_f32_16x16x32_bf16 v[108:111], v[48:51], v[132:135], v[108:111]
ds_read_b64_tr_b16 v[52:53], v23 offset:6152
ds_read_b64_tr_b16 v[54:55], v23 offset:6920
s_waitcnt lgkmcnt(10)
v_mfma_f32_16x16x32_bf16 v[112:115], v[60:63], v[132:135], v[112:115]
ds_read_b64_tr_b16 v[64:65], v23 offset:6208
ds_read_b64_tr_b16 v[66:67], v23 offset:6976
s_waitcnt lgkmcnt(10)
v_mfma_f32_16x16x32_bf16 v[116:119], v[72:75], v[132:135], v[116:119]
ds_read_b64_tr_b16 v[76:77], v23 offset:6216
ds_read_b64_tr_b16 v[78:79], v23 offset:6984
s_waitcnt lgkmcnt(10)
v_mfma_f32_16x16x32_bf16 v[120:123], v[84:87], v[132:135], v[120:123]
ds_read_b64_tr_b16 v[88:89], v23 offset:6272
ds_read_b64_tr_b16 v[90:91], v23 offset:7040
s_waitcnt lgkmcnt(10)
v_mfma_f32_16x16x32_bf16 v[124:127], v[96:99], v[132:135], v[124:127]
ds_read_b64_tr_b16 v[100:101], v23 offset:6280
ds_read_b64_tr_b16 v[102:103], v23 offset:7048
s_mov_b64 exec, 1
ds_add_u32 v4, v7 offset:144
s_mov_b64 exec, -1
s_waitcnt lgkmcnt(11)
v_mfma_f32_16x16x32_bf16 v[104:107], v[40:43], v[136:139], v[104:107]
s_waitcnt lgkmcnt(9)
v_mfma_f32_16x16x32_bf16 v[108:111], v[52:55], v[136:139], v[108:111]
s_waitcnt lgkmcnt(7)
v_mfma_f32_16x16x32_bf16 v[112:115], v[64:67], v[136:139], v[112:115]
s_waitcnt lgkmcnt(5)
v_mfma_f32_16x16x32_bf16 v[116:119], v[76:79], v[136:139], v[116:119]
s_waitcnt lgkmcnt(3)
v_mfma_f32_16x16x32_bf16 v[120:123], v[88:91], v[136:139], v[120:123]
s_waitcnt lgkmcnt(1)
v_mfma_f32_16x16x32_bf16 v[124:127], v[100:103], v[136:139], v[124:127]
s_cmp_ge_u32 s3, 4
s_cbranch_scc1 L_11
Lpoll_13:
ds_read_b32 v6, v4 offset:132
s_waitcnt lgkmcnt(0)
v_readfirstlane_b32 s57, v6
s_sub_u32 s15, s15, 1
s_cselect_b32 s57, 2, s57
s_cmp_ge_u32 s57, 2
s_cbranch_scc1 Lpd_14
s_sleep 1
s_branch Lpoll_13
Lpd_14:
ds_read_b128 v[152:155], v8 offset:0
ds_read_b128 v[156:159], v8 offset:64
ds_read_b128 v[160:163], v8 offset:128
s_mov_b64 exec, 1
ds_add_u32 v4, v7 offset:132
s_mov_b64 exec, -1
s_and_b32 s7, s3, 1
s_lshl_b32 s7, s7, 1
s_lshr_b32 s57, s3, 1
s_add_u32 s7, s7, s57
s_mul_i32 s7, s7, 3072
s_add_u32 s7, s7, 98304
s_sub_u32 s57, s7, s6
v_bfe_u32 v10, v1, 2, 1
v_lshlrev_b32 v10, 1, v10
v_xor_b32 v10, v10, v15
v_lshl_add_u32 v10, v10, 4, s6
v_mul_u32_u24 v6, 192, v22
v_add3_u32 v11, v6, v10, s57
s_waitcnt lgkmcnt(0)
v_mfma_f32_16x16x32_bf16 v[128:131], v[32:35], v[152:155], 0
v_add_u32 v6, 0, v1
v_mul_u32_u24 v164, 43691, v6
v_mfma_f32_16x16x32_bf16 v[132:135], v[44:47], v[152:155], 0
v_lshrrev_b32 v164, 19, v164
v_mul_u32_u24 v165, 12, v164
v_mfma_f32_16x16x32_bf16 v[136:139], v[56:59], v[152:155], 0
v_sub_u32 v6, v6, v165
v_bfe_u32 v165, v164, 2, 1
v_mfma_f32_16x16x32_bf16 v[140:143], v[68:71], v[152:155], 0
v_lshlrev_b32 v165, 1, v165
v_xor_b32 v6, v6, v165
v_mfma_f32_16x16x32_bf16 v[144:147], v[80:83], v[152:155], 0
v_mul_u32_u24 v164, 0x180, v164
v_lshl_add_u32 v15, v6, 4, v164
v_mfma_f32_16x16x32_bf16 v[148:151], v[92:95], v[152:155], 0
v_add_u32 v6, 64, v1
v_mul_u32_u24 v164, 43691, v6
v_mfma_f32_16x16x32_bf16 v[128:131], v[36:39], v[156:159], v[128:131]
v_lshrrev_b32 v164, 19, v164
v_mul_u32_u24 v165, 12, v164
v_mfma_f32_16x16x32_bf16 v[132:135], v[48:51], v[156:159], v[132:135]
v_sub_u32 v6, v6, v165
v_bfe_u32 v165, v164, 2, 1
v_mfma_f32_16x16x32_bf16 v[136:139], v[60:63], v[156:159], v[136:139]
v_lshlrev_b32 v165, 1, v165
v_xor_b32 v6, v6, v165
v_mfma_f32_16x16x32_bf16 v[140:143], v[72:75], v[156:159], v[140:143]
v_mul_u32_u24 v164, 0x180, v164
v_lshl_add_u32 v22, v6, 4, v164
v_mfma_f32_16x16x32_bf16 v[144:147], v[84:87], v[156:159], v[144:147]
v_subrev_u32 v22, 1024, v22
v_add_u32 v6, 128, v1
v_mfma_f32_16x16x32_bf16 v[148:151], v[96:99], v[156:159], v[148:151]
v_mul_u32_u24 v164, 43691, v6
v_lshrrev_b32 v164, 19, v164
v_mfma_f32_16x16x32_bf16 v[128:131], v[40:43], v[160:163], v[128:131]
v_mul_u32_u24 v165, 12, v164
v_sub_u32 v6, v6, v165
v_mfma_f32_16x16x32_bf16 v[132:135], v[52:55], v[160:163], v[132:135]
v_bfe_u32 v165, v164, 2, 1
v_lshlrev_b32 v165, 1, v165
v_mfma_f32_16x16x32_bf16 v[136:139], v[64:67], v[160:163], v[136:139]
v_xor_b32 v6, v6, v165
v_mul_u32_u24 v164, 0x180, v164
v_mfma_f32_16x16x32_bf16 v[140:143], v[76:79], v[160:163], v[140:143]
v_lshl_add_u32 v23, v6, 4, v164
v_subrev_u32 v23, 2048, v23
v_mfma_f32_16x16x32_bf16 v[144:147], v[88:91], v[160:163], v[144:147]
v_mov_b32 v1, v11
v_mfma_f32_16x16x32_bf16 v[148:151], v[100:103], v[160:163], v[148:151]
s_waitcnt vmcnt(5)
s_mov_b64 exec, 1
ds_add_u32 v4, v7 offset:160
s_mov_b64 exec, -1
s_waitcnt vmcnt(0)
s_branch L_12
L_11:
Lpoll_16:
ds_read_b32 v6, v4 offset:152
s_waitcnt lgkmcnt(0)
v_readfirstlane_b32 s57, v6
s_sub_u32 s15, s15, 1
s_cselect_b32 s57, 4, s57
s_cmp_ge_u32 s57, 4
s_cbranch_scc1 Lpd_17
s_sleep 1
s_branch Lpoll_16
Lpd_17:
s_add_u32 m0, s6, 0
s_add_u32 s57, s54, 0
buffer_load_dwordx4 v12, s[40:43], s57 offen offset:0 nt lds
buffer_load_dwordx4 v13, s[40:43], s57 offen offset:1024 nt lds
buffer_load_dwordx4 v14, s[40:43], s57 offen offset:2048 nt lds
s_add_u32 m0, s6, 3072
s_add_u32 s57, s54, 3072
buffer_load_dwordx4 v18, s[40:43], s57 offen offset:0 nt lds
buffer_load_dwordx4 v19, s[40:43], s57 offen offset:1024 nt lds
buffer_load_dwordx4 v20, s[40:43], s57 offen offset:2048 nt lds
s_waitcnt vmcnt(0)
L_12:
v_mov_b32 v152, 0x3f803f80
v_mov_b32 v153, 0x3f803f80
v_mov_b32 v154, 0x3f803f80
v_mov_b32 v155, 0x3f803f80
v_pk_add_f32 v[8:9], v[104:105], v[106:107]
v_pk_add_f32 v[8:9], v[8:9], v[108:109]
v_pk_add_f32 v[8:9], v[8:9], v[110:111]
v_pk_add_f32 v[8:9], v[8:9], v[112:113]
v_pk_add_f32 v[8:9], v[8:9], v[114:115]
v_pk_add_f32 v[8:9], v[8:9], v[116:117]
v_pk_add_f32 v[8:9], v[8:9], v[118:119]
v_pk_add_f32 v[8:9], v[8:9], v[120:121]
v_pk_add_f32 v[8:9], v[8:9], v[122:123]
v_pk_add_f32 v[8:9], v[8:9], v[124:125]
v_pk_add_f32 v[8:9], v[8:9], v[126:127]
v_add_f32 v8, v8, v9
s_nop 1
v_mfma_f32_16x16x4_f32 v[156:159], v30, v8, 0
ds_read_b128 v[32:35], v16 offset:0
ds_read_b128 v[36:39], v17 offset:0
ds_read_b128 v[40:43], v16 offset:128
ds_read_b128 v[44:47], v17 offset:128
ds_read_b128 v[48:51], v16 offset:256
ds_read_b128 v[52:55], v17 offset:256
s_waitcnt lgkmcnt(3)
v_mfma_f32_16x16x32_bf16 v[56:59], v[26:29], v[32:35], v[104:107]
v_mfma_f32_16x16x32_bf16 v[60:63], v[24:27], v[32:35], v[108:111]
s_nop 0
v_mfma_f32_16x16x32_bf16 v[160:163], v[152:155], v[32:35], v[156:159]
v_mfma_f32_16x16x32_bf16 v[64:67], v[26:29], v[36:39], v[112:115]
v_mfma_f32_16x16x32_bf16 v[68:71], v[24:27], v[36:39], v[116:119]
v_mfma_f32_16x16x32_bf16 v[160:163], v[152:155], v[36:39], v[160:163]
v_mfma_f32_16x16x32_bf16 v[72:75], v[26:29], v[40:43], v[120:123]
v_mfma_f32_16x16x32_bf16 v[76:79], v[24:27], v[40:43], v[124:127]
v_mfma_f32_16x16x32_bf16 v[160:163], v[152:155], v[40:43], v[160:163]
v_mul_f32 v8, v56, v56
v_mul_f32 v9, v57, v57
v_fmac_f32 v8, v58, v58
v_fmac_f32 v9, v59, v59
v_fmac_f32 v8, v60, v60
v_fmac_f32 v9, v61, v61
v_fmac_f32 v8, v62, v62
v_fmac_f32 v9, v63, v63
v_fmac_f32 v8, v64, v64
v_fmac_f32 v9, v65, v65
v_fmac_f32 v8, v66, v66
v_fmac_f32 v9, v67, v67
v_fmac_f32 v8, v68, v68
v_fmac_f32 v9, v69, v69
v_fmac_f32 v8, v70, v70
v_fmac_f32 v9, v71, v71
v_fmac_f32 v8, v72, v72
v_fmac_f32 v9, v73, v73
v_fmac_f32 v8, v74, v74
v_fmac_f32 v9, v75, v75
v_fmac_f32 v8, v76, v76
v_fmac_f32 v9, v77, v77
v_fmac_f32 v8, v78, v78
v_fmac_f32 v9, v79, v79
v_add_f32 v8, v8, v9
s_nop 1
v_mfma_f32_16x16x4_f32 v[32:35], v30, v8, 0
s_waitcnt lgkmcnt(0)
v_mfma_f32_16x16x32_bf16 v[80:83], v[26:29], v[44:47], v[104:107]
v_mfma_f32_16x16x32_bf16 v[84:87], v[24:27], v[44:47], v[108:111]
v_mfma_f32_16x16x32_bf16 v[164:167], v[152:155], v[44:47], v[156:159]
v_mfma_f32_16x16x32_bf16 v[88:91], v[26:29], v[48:51], v[112:115]
v_mfma_f32_16x16x32_bf16 v[92:95], v[24:27], v[48:51], v[116:119]
v_mfma_f32_16x16x32_bf16 v[164:167], v[152:155], v[48:51], v[164:167]
v_mfma_f32_16x16x32_bf16 v[96:99], v[26:29], v[52:55], v[120:123]
v_mfma_f32_16x16x32_bf16 v[100:103], v[24:27], v[52:55], v[124:127]
v_mfma_f32_16x16x32_bf16 v[164:167], v[152:155], v[52:55], v[164:167]
v_mul_f32 v160, 0xbc2aaaab, v160
s_nop 0
v_fma_f32 v32, v32, v0, v31
v_fma_f32 v32, -v160, v160, v32
v_max_f32 v32, v32, v31
v_rsq_f32 v10, v32
s_nop 0
v_mul_f32 v11, v160, v10
v_fma_f32 v56, v56, v10, v11
v_fma_f32 v57, v57, v10, v11
v_fma_f32 v58, v58, v10, v11
v_fma_f32 v59, v59, v10, v11
v_fma_f32 v60, v60, v10, v11
v_fma_f32 v61, v61, v10, v11
v_fma_f32 v62, v62, v10, v11
v_fma_f32 v63, v63, v10, v11
v_cvt_pk_bf16_f32 v56, v56, v57
v_cvt_pk_bf16_f32 v57, v58, v59
v_cvt_pk_bf16_f32 v58, v60, v61
v_cvt_pk_bf16_f32 v59, v62, v63
ds_write_b128 v2, v[56:59] offset:0
v_fma_f32 v64, v64, v10, v11
v_fma_f32 v65, v65, v10, v11
v_fma_f32 v66, v66, v10, v11
v_fma_f32 v67, v67, v10, v11
v_fma_f32 v68, v68, v10, v11
v_fma_f32 v69, v69, v10, v11
v_fma_f32 v70, v70, v10, v11
v_fma_f32 v71, v71, v10, v11
v_cvt_pk_bf16_f32 v64, v64, v65
v_cvt_pk_bf16_f32 v65, v66, v67
v_cvt_pk_bf16_f32 v66, v68, v69
v_cvt_pk_bf16_f32 v67, v70, v71
ds_write_b128 v2, v[64:67] offset:1024
v_fma_f32 v72, v72, v10, v11
v_fma_f32 v73, v73, v10, v11
v_fma_f32 v74, v74, v10, v11
v_fma_f32 v75, v75, v10, v11
v_fma_f32 v76, v76, v10, v11
v_fma_f32 v77, v77, v10, v11
v_fma_f32 v78, v78, v10, v11
v_fma_f32 v79, v79, v10, v11
v_cvt_pk_bf16_f32 v72, v72, v73
v_cvt_pk_bf16_f32 v73, v74, v75
v_cvt_pk_bf16_f32 v74, v76, v77
v_cvt_pk_bf16_f32 v75, v78, v79
ds_write_b128 v2, v[72:75] offset:2048
s_mov_b64 exec, 1
ds_add_u32 v3, v7 offset:0
s_mov_b64 exec, -1
v_mul_f32 v8, v80, v80
v_mul_f32 v9, v81, v81
v_fmac_f32 v8, v82, v82
v_fmac_f32 v9, v83, v83
v_fmac_f32 v8, v84, v84
v_fmac_f32 v9, v85, v85
v_fmac_f32 v8, v86, v86
v_fmac_f32 v9, v87, v87
v_fmac_f32 v8, v88, v88
v_fmac_f32 v9, v89, v89
v_fmac_f32 v8, v90, v90
v_fmac_f32 v9, v91, v91
v_fmac_f32 v8, v92, v92
v_fmac_f32 v9, v93, v93
v_fmac_f32 v8, v94, v94
v_fmac_f32 v9, v95, v95
v_fmac_f32 v8, v96, v96
v_fmac_f32 v9, v97, v97
v_fmac_f32 v8, v98, v98
v_fmac_f32 v9, v99, v99
v_fmac_f32 v8, v100, v100
v_fmac_f32 v9, v101, v101
v_fmac_f32 v8, v102, v102
v_fmac_f32 v9, v103, v103
v_add_f32 v8, v8, v9
s_nop 1
v_mfma_f32_16x16x4_f32 v[44:47], v30, v8, 0
v_mul_f32 v164, 0xbc2aaaab, v164
s_nop 10
v_fma_f32 v44, v44, v0, v31
v_fma_f32 v44, -v164, v164, v44
v_max_f32 v44, v44, v31
v_rsq_f32 v10, v44
s_nop 0
v_mul_f32 v11, v164, v10
v_fma_f32 v80, v80, v10, v11
v_fma_f32 v81, v81, v10, v11
v_fma_f32 v82, v82, v10, v11
v_fma_f32 v83, v83, v10, v11
v_fma_f32 v84, v84, v10, v11
v_fma_f32 v85, v85, v10, v11
v_fma_f32 v86, v86, v10, v11
v_fma_f32 v87, v87, v10, v11
v_cvt_pk_bf16_f32 v80, v80, v81
v_cvt_pk_bf16_f32 v81, v82, v83
v_cvt_pk_bf16_f32 v82, v84, v85
v_cvt_pk_bf16_f32 v83, v86, v87
ds_write_b128 v2, v[80:83] offset:3072
v_fma_f32 v88, v88, v10, v11
v_fma_f32 v89, v89, v10, v11
v_fma_f32 v90, v90, v10, v11
v_fma_f32 v91, v91, v10, v11
v_fma_f32 v92, v92, v10, v11
v_fma_f32 v93, v93, v10, v11
v_fma_f32 v94, v94, v10, v11
v_fma_f32 v95, v95, v10, v11
v_cvt_pk_bf16_f32 v88, v88, v89
v_cvt_pk_bf16_f32 v89, v90, v91
v_cvt_pk_bf16_f32 v90, v92, v93
v_cvt_pk_bf16_f32 v91, v94, v95
ds_write_b128 v2, v[88:91] offset:4096
v_fma_f32 v96, v96, v10, v11
v_fma_f32 v97, v97, v10, v11
v_fma_f32 v98, v98, v10, v11
v_fma_f32 v99, v99, v10, v11
v_fma_f32 v100, v100, v10, v11
v_fma_f32 v101, v101, v10, v11
v_fma_f32 v102, v102, v10, v11
v_fma_f32 v103, v103, v10, v11
v_cvt_pk_bf16_f32 v96, v96, v97
v_cvt_pk_bf16_f32 v97, v98, v99
v_cvt_pk_bf16_f32 v98, v100, v101
v_cvt_pk_bf16_f32 v99, v102, v103
ds_write_b128 v2, v[96:99] offset:5120
s_mov_b64 exec, 1
ds_add_u32 v3, v7 offset:8
s_mov_b64 exec, -1
Lpoll_20:
ds_read_b32 v6, v4 offset:144
s_waitcnt lgkmcnt(0)
v_readfirstlane_b32 s57, v6
s_sub_u32 s15, s15, 1
s_cselect_b32 s57, 8, s57
s_cmp_ge_u32 s57, 8
s_cbranch_scc1 Lpd_21
s_sleep 1
s_branch Lpoll_20
Lpd_21:
s_add_u32 m0, s6, 49152
s_add_u32 s57, s54, 73728
buffer_load_dwordx4 v12, s[40:43], s57 offen offset:0 nt lds
buffer_load_dwordx4 v13, s[40:43], s57 offen offset:1024 nt lds
buffer_load_dwordx4 v14, s[40:43], s57 offen offset:2048 nt lds
s_add_u32 m0, s6, 52224
s_add_u32 s57, s54, 76800
buffer_load_dwordx4 v18, s[40:43], s57 offen offset:0 nt lds
buffer_load_dwordx4 v19, s[40:43], s57 offen offset:1024 nt lds
buffer_load_dwordx4 v20, s[40:43], s57 offen offset:2048 nt lds
L_19:
s_setprio 2
s_cmp_ge_u32 s3, 4
s_cbranch_scc1 Hcls_24
s_setprio 2
s_mul_hi_u32 s57, s53, 0x15555556
s_mul_i32 s58, s57, 12
s_sub_u32 s58, s53, s58
s_mul_i32 s57, s57, 147456
s_mul_i32 s58, s58, 6144
s_add_u32 s54, s57, s58
s_bfe_u32 s57, s3, 0x10001
s_mul_i32 s57, s57, 73728
s_add_u32 s5, s54, s57
s_and_b32 s57, s3, 1
s_mul_i32 s57, s57, 192
s_add_u32 s5, s5, s57
s_waitcnt vmcnt(0)
ds_read_b128 v[32:35], v16 offset:49152
ds_read_b128 v[36:39], v17 offset:49152
ds_read_b128 v[40:43], v16 offset:49280
ds_read_b128 v[44:47], v17 offset:49280
ds_read_b128 v[48:51], v16 offset:49408
ds_read_b128 v[52:55], v17 offset:49408
s_waitcnt lgkmcnt(3)
v_mfma_f32_16x16x32_bf16 v[56:59], v[26:29], v[32:35], v[104:107]
v_mfma_f32_16x16x32_bf16 v[60:63], v[24:27], v[32:35], v[108:111]
v_mfma_f32_16x16x32_bf16 v[160:163], v[152:155], v[32:35], v[156:159]
v_mfma_f32_16x16x32_bf16 v[64:67], v[26:29], v[36:39], v[112:115]
v_mfma_f32_16x16x32_bf16 v[68:71], v[24:27], v[36:39], v[116:119]
v_mfma_f32_16x16x32_bf16 v[160:163], v[152:155], v[36:39], v[160:163]
v_mfma_f32_16x16x32_bf16 v[72:75], v[26:29], v[40:43], v[120:123]
v_mfma_f32_16x16x32_bf16 v[76:79], v[24:27], v[40:43], v[124:127]
v_mfma_f32_16x16x32_bf16 v[160:163], v[152:155], v[40:43], v[160:163]
v_mul_f32 v8, v56, v56
v_mul_f32 v9, v57, v57
v_fmac_f32 v8, v58, v58
v_fmac_f32 v9, v59, v59
v_fmac_f32 v8, v60, v60
v_fmac_f32 v9, v61, v61
v_fmac_f32 v8, v62, v62
v_fmac_f32 v9, v63, v63
v_fmac_f32 v8, v64, v64
v_fmac_f32 v9, v65, v65
v_fmac_f32 v8, v66, v66
v_fmac_f32 v9, v67, v67
v_fmac_f32 v8, v68, v68
v_fmac_f32 v9, v69, v69
v_fmac_f32 v8, v70, v70
v_fmac_f32 v9, v71, v71
v_fmac_f32 v8, v72, v72
v_fmac_f32 v9, v73, v73
v_fmac_f32 v8, v74, v74
v_fmac_f32 v9, v75, v75
v_fmac_f32 v8, v76, v76
v_fmac_f32 v9, v77, v77
v_fmac_f32 v8, v78, v78
v_fmac_f32 v9, v79, v79
v_add_f32 v8, v8, v9
s_nop 1
v_mfma_f32_16x16x4_f32 v[32:35], v30, v8, 0
s_waitcnt lgkmcnt(0)
v_mfma_f32_16x16x32_bf16 v[80:83], v[26:29], v[44:47], v[104:107]
v_mfma_f32_16x16x32_bf16 v[84:87], v[24:27], v[44:47], v[108:111]
v_mfma_f32_16x16x32_bf16 v[164:167], v[152:155], v[44:47], v[156:159]
v_mfma_f32_16x16x32_bf16 v[88:91], v[26:29], v[48:51], v[112:115]
v_mfma_f32_16x16x32_bf16 v[92:95], v[24:27], v[48:51], v[116:119]
v_mfma_f32_16x16x32_bf16 v[164:167], v[152:155], v[48:51], v[164:167]
v_mfma_f32_16x16x32_bf16 v[96:99], v[26:29], v[52:55], v[120:123]
v_mfma_f32_16x16x32_bf16 v[100:103], v[24:27], v[52:55], v[124:127]
v_mfma_f32_16x16x32_bf16 v[164:167], v[152:155], v[52:55], v[164:167]
v_mul_f32 v160, 0xbc2aaaab, v160
s_nop 0
v_fma_f32 v32, v32, v0, v31
v_fma_f32 v32, -v160, v160, v32
v_max_f32 v32, v32, v31
v_rsq_f32 v10, v32
s_nop 0
v_mul_f32 v11, v160, v10
v_fma_f32 v56, v56, v10, v11
v_fma_f32 v57, v57, v10, v11
v_fma_f32 v58, v58, v10, v11
v_fma_f32 v59, v59, v10, v11
v_fma_f32 v60, v60, v10, v11
v_fma_f32 v61, v61, v10, v11
v_fma_f32 v62, v62, v10, v11
v_fma_f32 v63, v63, v10, v11
v_cvt_pk_bf16_f32 v56, v56, v57
v_cvt_pk_bf16_f32 v57, v58, v59
v_cvt_pk_bf16_f32 v58, v60, v61
v_cvt_pk_bf16_f32 v59, v62, v63
ds_write_b128 v2, v[56:59] offset:49152
v_fma_f32 v64, v64, v10, v11
v_fma_f32 v65, v65, v10, v11
v_fma_f32 v66, v66, v10, v11
v_fma_f32 v67, v67, v10, v11
v_fma_f32 v68, v68, v10, v11
v_fma_f32 v69, v69, v10, v11
v_fma_f32 v70, v70, v10, v11
v_fma_f32 v71, v71, v10, v11
v_cvt_pk_bf16_f32 v64, v64, v65
v_cvt_pk_bf16_f32 v65, v66, v67
v_cvt_pk_bf16_f32 v66, v68, v69
v_cvt_pk_bf16_f32 v67, v70, v71
ds_write_b128 v2, v[64:67] offset:50176
v_fma_f32 v72, v72, v10, v11
v_fma_f32 v73, v73, v10, v11
v_fma_f32 v74, v74, v10, v11
v_fma_f32 v75, v75, v10, v11
v_fma_f32 v76, v76, v10, v11
v_fma_f32 v77, v77, v10, v11
v_fma_f32 v78, v78, v10, v11
v_fma_f32 v79, v79, v10, v11
v_cvt_pk_bf16_f32 v72, v72, v73
v_cvt_pk_bf16_f32 v73, v74, v75
v_cvt_pk_bf16_f32 v74, v76, v77
v_cvt_pk_bf16_f32 v75, v78, v79
ds_write_b128 v2, v[72:75] offset:51200
s_mov_b64 exec, 1
ds_add_u32 v3, v7 offset:32
s_mov_b64 exec, -1
v_mul_f32 v8, v80, v80
v_mul_f32 v9, v81, v81
v_fmac_f32 v8, v82, v82
v_fmac_f32 v9, v83, v83
v_fmac_f32 v8, v84, v84
v_fmac_f32 v9, v85, v85
v_fmac_f32 v8, v86, v86
v_fmac_f32 v9, v87, v87
v_fmac_f32 v8, v88, v88
v_fmac_f32 v9, v89, v89
v_fmac_f32 v8, v90, v90
v_fmac_f32 v9, v91, v91
v_fmac_f32 v8, v92, v92
v_fmac_f32 v9, v93, v93
v_fmac_f32 v8, v94, v94
v_fmac_f32 v9, v95, v95
v_fmac_f32 v8, v96, v96
v_fmac_f32 v9, v97, v97
v_fmac_f32 v8, v98, v98
v_fmac_f32 v9, v99, v99
v_fmac_f32 v8, v100, v100
v_fmac_f32 v9, v101, v101
v_fmac_f32 v8, v102, v102
v_fmac_f32 v9, v103, v103
v_add_f32 v8, v8, v9
s_nop 1
v_mfma_f32_16x16x4_f32 v[44:47], v30, v8, 0
v_mul_f32 v164, 0xbc2aaaab, v164
s_nop 10
v_fma_f32 v44, v44, v0, v31
v_fma_f32 v44, -v164, v164, v44
v_max_f32 v44, v44, v31
v_rsq_f32 v10, v44
s_nop 0
v_mul_f32 v11, v164, v10
v_fma_f32 v80, v80, v10, v11
v_fma_f32 v81, v81, v10, v11
v_fma_f32 v82, v82, v10, v11
v_fma_f32 v83, v83, v10, v11
v_fma_f32 v84, v84, v10, v11
v_fma_f32 v85, v85, v10, v11
v_fma_f32 v86, v86, v10, v11
v_fma_f32 v87, v87, v10, v11
v_cvt_pk_bf16_f32 v80, v80, v81
v_cvt_pk_bf16_f32 v81, v82, v83
v_cvt_pk_bf16_f32 v82, v84, v85
v_cvt_pk_bf16_f32 v83, v86, v87
ds_write_b128 v2, v[80:83] offset:52224
v_fma_f32 v88, v88, v10, v11
v_fma_f32 v89, v89, v10, v11
v_fma_f32 v90, v90, v10, v11
v_fma_f32 v91, v91, v10, v11
v_fma_f32 v92, v92, v10, v11
v_fma_f32 v93, v93, v10, v11
v_fma_f32 v94, v94, v10, v11
v_fma_f32 v95, v95, v10, v11
v_cvt_pk_bf16_f32 v88, v88, v89
v_cvt_pk_bf16_f32 v89, v90, v91
v_cvt_pk_bf16_f32 v90, v92, v93
v_cvt_pk_bf16_f32 v91, v94, v95
ds_write_b128 v2, v[88:91] offset:53248
v_fma_f32 v96, v96, v10, v11
v_fma_f32 v97, v97, v10, v11
v_fma_f32 v98, v98, v10, v11
v_fma_f32 v99, v99, v10, v11
v_fma_f32 v100, v100, v10, v11
v_fma_f32 v101, v101, v10, v11
v_fma_f32 v102, v102, v10, v11
v_fma_f32 v103, v103, v10, v11
v_cvt_pk_bf16_f32 v96, v96, v97
v_cvt_pk_bf16_f32 v97, v98, v99
v_cvt_pk_bf16_f32 v98, v100, v101
v_cvt_pk_bf16_f32 v99, v102, v103
ds_write_b128 v2, v[96:99] offset:54272
s_mov_b64 exec, 1
ds_add_u32 v3, v7 offset:40
s_mov_b64 exec, -1
s_mov_b32 m0, s7
s_nop 0
buffer_load_dwordx4 v15, s[40:43], s5 offen offset:0 nt lds
buffer_load_dwordx4 v22, s[40:43], s5 offen offset:1024 nt lds
buffer_load_dwordx4 v23, s[40:43], s5 offen offset:2048 nt lds
v_pk_add_f32 v[8:9], v[128:129], v[130:131]
v_pk_add_f32 v[8:9], v[8:9], v[132:133]
v_pk_add_f32 v[8:9], v[8:9], v[134:135]
v_pk_add_f32 v[8:9], v[8:9], v[136:137]
v_pk_add_f32 v[8:9], v[8:9], v[138:139]
v_pk_add_f32 v[8:9], v[8:9], v[140:141]
v_pk_add_f32 v[8:9], v[8:9], v[142:143]
v_pk_add_f32 v[8:9], v[8:9], v[144:145]
v_pk_add_f32 v[8:9], v[8:9], v[146:147]
v_pk_add_f32 v[8:9], v[8:9], v[148:149]
v_pk_add_f32 v[8:9], v[8:9], v[150:151]
v_add_f32 v8, v8, v9
s_nop 1
v_mfma_f32_16x16x4_f32 v[156:159], v30, v8, 0
s_sub_u32 s57, s7, s6
v_add_u32 v2, s57, v2
s_and_b32 s57, s3, 2
v_lshl_add_u32 v3, s57, 1, v4
s_setprio 2
s_waitcnt vmcnt(0)
ds_read_b128 v[32:35], v1 offset:0
ds_read_b128 v[36:39], v1 offset:64
ds_read_b128 v[40:43], v1 offset:128
s_waitcnt lgkmcnt(0)
v_mfma_f32_16x16x32_bf16 v[56:59], v[26:29], v[32:35], v[128:131]
v_mfma_f32_16x16x32_bf16 v[60:63], v[24:27], v[32:35], v[132:135]
v_mfma_f32_16x16x32_bf16 v[160:163], v[152:155], v[32:35], v[156:159]
v_mfma_f32_16x16x32_bf16 v[64:67], v[26:29], v[36:39], v[136:139]
v_mfma_f32_16x16x32_bf16 v[68:71], v[24:27], v[36:39], v[140:143]
v_mfma_f32_16x16x32_bf16 v[160:163], v[152:155], v[36:39], v[160:163]
v_mfma_f32_16x16x32_bf16 v[72:75], v[26:29], v[40:43], v[144:147]
v_mfma_f32_16x16x32_bf16 v[76:79], v[24:27], v[40:43], v[148:151]
v_mfma_f32_16x16x32_bf16 v[160:163], v[152:155], v[40:43], v[160:163]
v_mul_f32 v8, v56, v56
v_mul_f32 v9, v57, v57
v_fmac_f32 v8, v58, v58
v_fmac_f32 v9, v59, v59
v_fmac_f32 v8, v60, v60
v_fmac_f32 v9, v61, v61
v_fmac_f32 v8, v62, v62
v_fmac_f32 v9, v63, v63
v_fmac_f32 v8, v64, v64
v_fmac_f32 v9, v65, v65
v_fmac_f32 v8, v66, v66
v_fmac_f32 v9, v67, v67
v_fmac_f32 v8, v68, v68
v_fmac_f32 v9, v69, v69
v_fmac_f32 v8, v70, v70
v_fmac_f32 v9, v71, v71
v_fmac_f32 v8, v72, v72
v_fmac_f32 v9, v73, v73
v_fmac_f32 v8, v74, v74
v_fmac_f32 v9, v75, v75
v_fmac_f32 v8, v76, v76
v_fmac_f32 v9, v77, v77
v_fmac_f32 v8, v78, v78
v_fmac_f32 v9, v79, v79
v_add_f32 v8, v8, v9
s_nop 1
v_mfma_f32_16x16x4_f32 v[32:35], v30, v8, 0
v_mul_f32 v160, 0xbc2aaaab, v160
s_nop 10
v_fma_f32 v32, v32, v0, v31
v_fma_f32 v32, -v160, v160, v32
v_max_f32 v32, v32, v31
v_rsq_f32 v10, v32
s_nop 0
v_mul_f32 v11, v160, v10
v_fma_f32 v56, v56, v10, v11
v_fma_f32 v57, v57, v10, v11
v_fma_f32 v58, v58, v10, v11
v_fma_f32 v59, v59, v10, v11
v_fma_f32 v60, v60, v10, v11
v_fma_f32 v61, v61, v10, v11
v_fma_f32 v62, v62, v10, v11
v_fma_f32 v63, v63, v10, v11
v_cvt_pk_bf16_f32 v56, v56, v57
v_cvt_pk_bf16_f32 v57, v58, v59
v_cvt_pk_bf16_f32 v58, v60, v61
v_cvt_pk_bf16_f32 v59, v62, v63
ds_write_b128 v2, v[56:59] offset:0
v_fma_f32 v64, v64, v10, v11
v_fma_f32 v65, v65, v10, v11
v_fma_f32 v66, v66, v10, v11
v_fma_f32 v67, v67, v10, v11
v_fma_f32 v68, v68, v10, v11
v_fma_f32 v69, v69, v10, v11
v_fma_f32 v70, v70, v10, v11
v_fma_f32 v71, v71, v10, v11
v_cvt_pk_bf16_f32 v64, v64, v65
v_cvt_pk_bf16_f32 v65, v66, v67
v_cvt_pk_bf16_f32 v66, v68, v69
v_cvt_pk_bf16_f32 v67, v70, v71
ds_write_b128 v2, v[64:67] offset:1024
v_fma_f32 v72, v72, v10, v11
v_fma_f32 v73, v73, v10, v11
v_fma_f32 v74, v74, v10, v11
v_fma_f32 v75, v75, v10, v11
v_fma_f32 v76, v76, v10, v11
v_fma_f32 v77, v77, v10, v11
v_fma_f32 v78, v78, v10, v11
v_fma_f32 v79, v79, v10, v11
v_cvt_pk_bf16_f32 v72, v72, v73
v_cvt_pk_bf16_f32 v73, v74, v75
v_cvt_pk_bf16_f32 v74, v76, v77
v_cvt_pk_bf16_f32 v75, v78, v79
ds_write_b128 v2, v[72:75] offset:2048
s_mov_b64 exec, 1
ds_add_u32 v3, v7 offset:64
s_mov_b64 exec, -1
s_branch Hend_23
Hcls_24:
s_waitcnt vmcnt(0)
ds_read_b128 v[32:35], v16 offset:49152
ds_read_b128 v[36:39], v17 offset:49152
ds_read_b128 v[40:43], v16 offset:49280
ds_read_b128 v[44:47], v17 offset:49280
ds_read_b128 v[48:51], v16 offset:49408
ds_read_b128 v[52:55], v17 offset:49408
s_waitcnt lgkmcnt(3)
v_mfma_f32_16x16x32_bf16 v[56:59], v[26:29], v[32:35], v[104:107]
v_mfma_f32_16x16x32_bf16 v[60:63], v[24:27], v[32:35], v[108:111]
v_mfma_f32_16x16x32_bf16 v[160:163], v[152:155], v[32:35], v[156:159]
v_mfma_f32_16x16x32_bf16 v[64:67], v[26:29], v[36:39], v[112:115]
v_mfma_f32_16x16x32_bf16 v[68:71], v[24:27], v[36:39], v[116:119]
v_mfma_f32_16x16x32_bf16 v[160:163], v[152:155], v[36:39], v[160:163]
v_mfma_f32_16x16x32_bf16 v[72:75], v[26:29], v[40:43], v[120:123]
v_mfma_f32_16x16x32_bf16 v[76:79], v[24:27], v[40:43], v[124:127]
v_mfma_f32_16x16x32_bf16 v[160:163], v[152:155], v[40:43], v[160:163]
v_mul_f32 v8, v56, v56
v_mul_f32 v9, v57, v57
v_fmac_f32 v8, v58, v58
v_fmac_f32 v9, v59, v59
v_fmac_f32 v8, v60, v60
v_fmac_f32 v9, v61, v61
v_fmac_f32 v8, v62, v62
v_fmac_f32 v9, v63, v63
v_fmac_f32 v8, v64, v64
v_fmac_f32 v9, v65, v65
v_fmac_f32 v8, v66, v66
v_fmac_f32 v9, v67, v67
v_fmac_f32 v8, v68, v68
v_fmac_f32 v9, v69, v69
v_fmac_f32 v8, v70, v70
v_fmac_f32 v9, v71, v71
v_fmac_f32 v8, v72, v72
v_fmac_f32 v9, v73, v73
v_fmac_f32 v8, v74, v74
v_fmac_f32 v9, v75, v75
v_fmac_f32 v8, v76, v76
v_fmac_f32 v9, v77, v77
v_fmac_f32 v8, v78, v78
v_fmac_f32 v9, v79, v79
v_add_f32 v8, v8, v9
s_nop 1
v_mfma_f32_16x16x4_f32 v[32:35], v30, v8, 0
s_waitcnt lgkmcnt(0)
v_mfma_f32_16x16x32_bf16 v[80:83], v[26:29], v[44:47], v[104:107]
v_mfma_f32_16x16x32_bf16 v[84:87], v[24:27], v[44:47], v[108:111]
v_mfma_f32_16x16x32_bf16 v[164:167], v[152:155], v[44:47], v[156:159]
v_mfma_f32_16x16x32_bf16 v[88:91], v[26:29], v[48:51], v[112:115]
v_mfma_f32_16x16x32_bf16 v[92:95], v[24:27], v[48:51], v[116:119]
v_mfma_f32_16x16x32_bf16 v[164:167], v[152:155], v[48:51], v[164:167]
v_mfma_f32_16x16x32_bf16 v[96:99], v[26:29], v[52:55], v[120:123]
v_mfma_f32_16x16x32_bf16 v[100:103], v[24:27], v[52:55], v[124:127]
v_mfma_f32_16x16x32_bf16 v[164:167], v[152:155], v[52:55], v[164:167]
v_mul_f32 v160, 0xbc2aaaab, v160
s_nop 0
v_fma_f32 v32, v32, v0, v31
v_fma_f32 v32, -v160, v160, v32
v_max_f32 v32, v32, v31
v_rsq_f32 v10, v32
s_nop 0
v_mul_f32 v11, v160, v10
v_fma_f32 v56, v56, v10, v11
v_fma_f32 v57, v57, v10, v11
v_fma_f32 v58, v58, v10, v11
v_fma_f32 v59, v59, v10, v11
v_fma_f32 v60, v60, v10, v11
v_fma_f32 v61, v61, v10, v11
v_fma_f32 v62, v62, v10, v11
v_fma_f32 v63, v63, v10, v11
v_cvt_pk_bf16_f32 v56, v56, v57
v_cvt_pk_bf16_f32 v57, v58, v59
v_cvt_pk_bf16_f32 v58, v60, v61
v_cvt_pk_bf16_f32 v59, v62, v63
ds_write_b128 v2, v[56:59] offset:49152
v_fma_f32 v64, v64, v10, v11
v_fma_f32 v65, v65, v10, v11
v_fma_f32 v66, v66, v10, v11
v_fma_f32 v67, v67, v10, v11
v_fma_f32 v68, v68, v10, v11
v_fma_f32 v69, v69, v10, v11
v_fma_f32 v70, v70, v10, v11
v_fma_f32 v71, v71, v10, v11
v_cvt_pk_bf16_f32 v64, v64, v65
v_cvt_pk_bf16_f32 v65, v66, v67
v_cvt_pk_bf16_f32 v66, v68, v69
v_cvt_pk_bf16_f32 v67, v70, v71
ds_write_b128 v2, v[64:67] offset:50176
v_fma_f32 v72, v72, v10, v11
v_fma_f32 v73, v73, v10, v11
v_fma_f32 v74, v74, v10, v11
v_fma_f32 v75, v75, v10, v11
v_fma_f32 v76, v76, v10, v11
v_fma_f32 v77, v77, v10, v11
v_fma_f32 v78, v78, v10, v11
v_fma_f32 v79, v79, v10, v11
v_cvt_pk_bf16_f32 v72, v72, v73
v_cvt_pk_bf16_f32 v73, v74, v75
v_cvt_pk_bf16_f32 v74, v76, v77
v_cvt_pk_bf16_f32 v75, v78, v79
ds_write_b128 v2, v[72:75] offset:51200
s_mov_b64 exec, 1
ds_add_u32 v3, v7 offset:32
s_mov_b64 exec, -1
v_mul_f32 v8, v80, v80
v_mul_f32 v9, v81, v81
v_fmac_f32 v8, v82, v82
v_fmac_f32 v9, v83, v83
v_fmac_f32 v8, v84, v84
v_fmac_f32 v9, v85, v85
v_fmac_f32 v8, v86, v86
v_fmac_f32 v9, v87, v87
v_fmac_f32 v8, v88, v88
v_fmac_f32 v9, v89, v89
v_fmac_f32 v8, v90, v90
v_fmac_f32 v9, v91, v91
v_fmac_f32 v8, v92, v92
v_fmac_f32 v9, v93, v93
v_fmac_f32 v8, v94, v94
v_fmac_f32 v9, v95, v95
v_fmac_f32 v8, v96, v96
v_fmac_f32 v9, v97, v97
v_fmac_f32 v8, v98, v98
v_fmac_f32 v9, v99, v99
v_fmac_f32 v8, v100, v100
v_fmac_f32 v9, v101, v101
v_fmac_f32 v8, v102, v102
v_fmac_f32 v9, v103, v103
v_add_f32 v8, v8, v9
s_nop 1
v_mfma_f32_16x16x4_f32 v[44:47], v30, v8, 0
v_mul_f32 v164, 0xbc2aaaab, v164
s_nop 10
v_fma_f32 v44, v44, v0, v31
v_fma_f32 v44, -v164, v164, v44
v_max_f32 v44, v44, v31
v_rsq_f32 v10, v44
s_nop 0
v_mul_f32 v11, v164, v10
v_fma_f32 v80, v80, v10, v11
v_fma_f32 v81, v81, v10, v11
v_fma_f32 v82, v82, v10, v11
v_fma_f32 v83, v83, v10, v11
v_fma_f32 v84, v84, v10, v11
v_fma_f32 v85, v85, v10, v11
v_fma_f32 v86, v86, v10, v11
v_fma_f32 v87, v87, v10, v11
v_cvt_pk_bf16_f32 v80, v80, v81
v_cvt_pk_bf16_f32 v81, v82, v83
v_cvt_pk_bf16_f32 v82, v84, v85
v_cvt_pk_bf16_f32 v83, v86, v87
ds_write_b128 v2, v[80:83] offset:52224
v_fma_f32 v88, v88, v10, v11
v_fma_f32 v89, v89, v10, v11
v_fma_f32 v90, v90, v10, v11
v_fma_f32 v91, v91, v10, v11
v_fma_f32 v92, v92, v10, v11
v_fma_f32 v93, v93, v10, v11
v_fma_f32 v94, v94, v10, v11
v_fma_f32 v95, v95, v10, v11
v_cvt_pk_bf16_f32 v88, v88, v89
v_cvt_pk_bf16_f32 v89, v90, v91
v_cvt_pk_bf16_f32 v90, v92, v93
v_cvt_pk_bf16_f32 v91, v94, v95
ds_write_b128 v2, v[88:91] offset:53248
v_fma_f32 v96, v96, v10, v11
v_fma_f32 v97, v97, v10, v11
v_fma_f32 v98, v98, v10, v11
v_fma_f32 v99, v99, v10, v11
v_fma_f32 v100, v100, v10, v11
v_fma_f32 v101, v101, v10, v11
v_fma_f32 v102, v102, v10, v11
v_fma_f32 v103, v103, v10, v11
v_cvt_pk_bf16_f32 v96, v96, v97
v_cvt_pk_bf16_f32 v97, v98, v99
v_cvt_pk_bf16_f32 v98, v100, v101
v_cvt_pk_bf16_f32 v99, v102, v103
ds_write_b128 v2, v[96:99] offset:54272
s_mov_b64 exec, 1
ds_add_u32 v3, v7 offset:40
s_mov_b64 exec, -1
Lpoll_25:
ds_read_b32 v6, v4 offset:96
s_waitcnt lgkmcnt(0)
v_readfirstlane_b32 s57, v6
s_sub_u32 s15, s15, 1
s_cselect_b32 s57, 4, s57
s_cmp_ge_u32 s57, 4
s_cbranch_scc1 Lpd_26
s_sleep 1
s_branch Lpoll_25
Lpd_26:
s_mov_b32 s44, s28
s_mov_b32 s45, s29
s_mov_b32 s46, 18432
s_mov_b32 s47, 0x20000
s_sub_u32 s52, s3, 4
s_lshl_b32 s57, s52, 12
s_add_u32 s59, s57, 110592
s_mov_b32 m0, s59
s_nop 0
buffer_load_dwordx4 v5, s[44:47], s57 offen offset:0 lds
buffer_load_dwordx4 v5, s[44:47], s57 offen offset:1024 lds
buffer_load_dwordx4 v5, s[44:47], s57 offen offset:2048 lds
buffer_load_dwordx4 v5, s[44:47], s57 offen offset:3072 lds
s_and_b32 s57, s52, 1
s_lshl_b32 s57, s57, 10
s_add_u32 s57, s57, 16384
s_add_u32 s59, s57, 110592
s_mov_b32 m0, s59
s_cmp_ge_u32 s52, 2
s_cbranch_scc1 L_28
buffer_load_dwordx4 v5, s[44:47], s57 offen lds
L_28:
v_mov_b32 v128, 0
v_mov_b32 v129, 0
v_mov_b32 v130, 0
v_mov_b32 v131, 0
Lpoll_29:
ds_read_b32 v6, v4 offset:132
s_waitcnt lgkmcnt(0)
v_readfirstlane_b32 s57, v6
s_sub_u32 s15, s15, 1
s_cselect_b32 s57, 6, s57
s_cmp_ge_u32 s57, 6
s_cbranch_scc1 Lpd_30
s_sleep 1
s_branch Lpoll_29
Lpd_30:
s_lshl_b32 s57, s52, 10
s_add_u32 s57, s57, 156944
v_add_u32 v15, s57, v5
v_add_u32 v6, 161040, v5
ds_write_b128 v15, v[128:131]
s_mov_b64 exec, 0xffff
ds_write_b128 v6, v[128:131]
s_mov_b64 exec, -1
s_waitcnt vmcnt(0)
s_mov_b64 exec, 1
ds_add_u32 v4, v7 offset:80
s_mov_b64 exec, -1
Hend_23:
s_cmp_lt_u32 s2, 16
s_cbranch_scc1 L_fin
s_endpgm
L_fin:
s_mov_b32 s48, s38
s_mov_b32 s49, s39
s_mov_b32 s50, 2097152
s_mov_b32 s51, 0x20000
s_add_u32 s14, s14, 0x9e3779b9
s_setprio 0
v_mbcnt_lo_u32_b32 v1, -1, 0
v_mbcnt_hi_u32_b32 v1, -1, v1
v_lshlrev_b32 v2, 4, v1
v_mov_b32 v3, 156688
s_and_b32 s13, s14, 0xbfffbfff
s_lshl_b32 s60, s2, 16
s_lshl_b32 s57, s3, 13
s_add_u32 s60, s60, s57
s_add_u32 s61, s60, 4096
s_lshl_b32 s62, s2, 13
s_lshl_b32 s57, s3, 10
s_add_u32 s62, s62, s57
s_add_u32 s62, s62, 1048576
Lpoll_32:
ds_read_b32 v4, v3 offset:156
s_waitcnt lgkmcnt(0)
v_readfirstlane_b32 s57, v4
s_sub_u32 s15, s15, 1
s_cselect_b32 s57, 1, s57
s_cmp_ge_u32 s57, 1
s_cbranch_scc1 Lpd_33
s_sleep 1
s_branch Lpoll_32
Lpd_33:
s_mov_b32 s44, s30
s_mov_b32 s45, s31
s_mov_b32 s46, 18432
s_mov_b32 s47, 0x20000
s_lshl_b32 s57, s3, 10
s_add_u32 s57, s57, 0
s_add_u32 s58, s57, 129024
s_mov_b32 m0, s58
s_nop 0
buffer_load_dwordx4 v2, s[44:47], s57 offen lds
s_lshl_b32 s57, s3, 10
s_add_u32 s57, s57, 8192
s_add_u32 s58, s57, 129024
s_mov_b32 m0, s58
s_nop 0
buffer_load_dwordx4 v2, s[44:47], s57 offen lds
s_cmp_ge_u32 s3, 2
s_cbranch_scc1 F_skip
s_lshl_b32 s57, s3, 10
s_add_u32 s57, s57, 16384
s_add_u32 s58, s57, 129024
s_mov_b32 m0, s58
s_nop 0
buffer_load_dwordx4 v2, s[44:47], s57 offen lds
F_skip:
s_mov_b32 s44, s16
s_mov_b32 s45, s17
s_mov_b32 s46, 3072
s_mov_b32 s47, 0x20000
v_lshrrev_b32 v8, 4, v1
v_and_b32 v6, 15, v1
v_lshlrev_b32 v6, 1, v6
s_mul_i32 s7, s2, 192
s_lshl_b32 s57, s3, 5
s_add_u32 s7, s7, s57
buffer_load_ushort v48, v6, s[44:47], s7 offen
s_mov_b64 exec, 1
buffer_load_dwordx4 v[64:67], v2, s[48:51], s60 offen offset:0 sc0 sc1
buffer_load_dwordx4 v[96:99], v2, s[48:51], s62 offen sc0 sc1
s_mov_b64 exec, -1
s_mov_b32 s44, s34
s_mov_b32 s45, s35
s_mov_b32 s46, 3072
s_mov_b32 s47, 0x20000
v_and_b32 v4, 15, v1
v_lshrrev_b32 v5, 1, v4
v_and_b32 v50, 1, v1
v_lshlrev_b32 v50, 4, v50
v_mov_b32 v9, 0x3f80
v_lshlrev_b32 v50, v50, v9
v_cmp_eq_u32 vcc, 0, v5
s_nop 1
v_cndmask_b32 v12, 0, v50, vcc
v_cmp_eq_u32 vcc, 1, v5
s_nop 1
v_cndmask_b32 v13, 0, v50, vcc
v_cmp_eq_u32 vcc, 2, v5
s_nop 1
v_cndmask_b32 v14, 0, v50, vcc
v_cmp_eq_u32 vcc, 3, v5
s_nop 1
v_cndmask_b32 v15, 0, v50, vcc
v_cmp_gt_u32 s[22:23], 16, v1
v_mul_u32_u24 v49, 416, v8
v_and_b32 v50, 3, v1
v_lshl_add_u32 v49, v50, 2, v49
v_add_u32 v49, 160400, v49
v_mov_b32 v53, 1.0
v_bfe_u32 v5, v1, 3, 1
v_mul_u32_u24 v50, 48, v5
v_bfe_u32 v10, v1, 0, 2
v_lshl_add_u32 v50, v10, 2, v50
v_bfe_u32 v10, v1, 2, 1
v_lshl_add_u32 v9, v10, 5, v50
v_lshl_add_u32 v50, v10, 1, v50
v_add_u32 v50, 16, v50
v_cmp_eq_u32 vcc, 0, v8
s_nop 1
v_cndmask_b32 v9, v50, v9, vcc
s_mul_i32 s57, s3, 416
s_add_u32 s57, s57, 160016
v_lshl_add_u32 v9, v9, 2, s57
v_lshl_add_u32 v11, v1, 3, s57
v_and_b32 v50, 7, v1
v_mul_u32_u24 v10, 416, v50
v_add_u32 v10, 160016, v10
v_lshl_add_u32 v5, v8, 5, v10
v_cmp_le_u32 s[18:19], 3, v8
v_cmp_le_u32 s[10:11], 2, v8
v_cmp_le_u32 s[20:21], 1, v8
v_lshrrev_b32 v50, 2, v4
v_lshl_add_u32 v50, v8, 3, v50
v_mul_u32_u24 v50, 192, v50
v_and_b32 v4, 3, v1
v_lshl_add_u32 v50, v4, 3, v50
s_lshl_b32 s57, s3, 5
s_add_u32 s57, s57, 129024
v_add_u32 v50, s57, v50
s_mov_b64 s[52:53], 0
s_mov_b64 s[16:17], 0
s_mov_b32 s12, 0
s_cmp_lt_u32 s3, 1
s_cbranch_scc1 F_wr
F_back:
s_mov_b64 exec, -1
s_mov_b64 s[52:53], -1
s_mov_b64 s[16:17], s[22:23]
s_mov_b32 s12, 8
s_waitcnt vmcnt(0)
v_lshlrev_b32 v52, 16, v48
Lpoll_35:
ds_read_b32 v4, v3 offset:148
s_waitcnt lgkmcnt(0)
v_readfirstlane_b32 s57, v4
s_sub_u32 s15, s15, 1
s_cselect_b32 s57, 4, s57
s_cmp_ge_u32 s57, 4
s_cbranch_scc1 Lpd_36
s_sleep 6
s_branch Lpoll_35
Lpd_36:
buffer_load_dwordx4 v[64:67], v2, s[48:51], s60 offen offset:0 sc0 sc1
buffer_load_dwordx4 v[68:71], v2, s[48:51], s60 offen offset:1024 sc0 sc1
buffer_load_dwordx4 v[72:75], v2, s[48:51], s60 offen offset:2048 sc0 sc1
buffer_load_dwordx4 v[76:79], v2, s[48:51], s60 offen offset:3072 sc0 sc1
buffer_load_dwordx4 v[80:83], v2, s[48:51], s61 offen offset:0 sc0 sc1
buffer_load_dwordx4 v[84:87], v2, s[48:51], s61 offen offset:1024 sc0 sc1
buffer_load_dwordx4 v[88:91], v2, s[48:51], s61 offen offset:2048 sc0 sc1
buffer_load_dwordx4 v[92:95], v2, s[48:51], s61 offen offset:3072 sc0 sc1
buffer_load_dwordx4 v[96:99], v2, s[48:51], s62 offen sc0 sc1
F_loop:
s_waitcnt vmcnt(0)
v_cmp_ne_u32 s[42:43], s13, v99
v_mfma_f32_16x16x32_bf16 v[56:59], v[12:15], v[96:99], 0
v_cmp_ne_u32 s[24:25], s13, v67
v_mfma_f32_16x16x32_bf16 v[16:19], v[12:15], v[64:67], 0
s_or_b64 vcc, s[24:25], s[42:43]
v_cmp_ne_u32 s[26:27], s13, v71
v_mfma_f32_16x16x32_bf16 v[60:63], v[12:15], v[68:71], 0
s_or_b64 vcc, vcc, s[26:27]
v_cmp_ne_u32 s[28:29], s13, v75
v_mfma_f32_16x16x32_bf16 v[16:19], v[12:15], v[72:75], v[16:19]
s_or_b64 vcc, vcc, s[28:29]
v_cmp_ne_u32 s[30:31], s13, v79
v_mfma_f32_16x16x32_bf16 v[60:63], v[12:15], v[76:79], v[60:63]
s_or_b64 vcc, vcc, s[30:31]
v_cmp_ne_u32 s[32:33], s13, v83
v_mfma_f32_16x16x32_bf16 v[16:19], v[12:15], v[80:83], v[16:19]
s_or_b64 vcc, vcc, s[32:33]
v_cmp_ne_u32 s[34:35], s13, v87
v_mfma_f32_16x16x32_bf16 v[60:63], v[12:15], v[84:87], v[60:63]
s_or_b64 vcc, vcc, s[34:35]
v_cmp_ne_u32 s[36:37], s13, v91
v_mfma_f32_16x16x32_bf16 v[16:19], v[12:15], v[88:91], v[16:19]
s_or_b64 vcc, vcc, s[36:37]
v_cmp_ne_u32 s[40:41], s13, v95
v_mfma_f32_16x16x32_bf16 v[60:63], v[12:15], v[92:95], v[60:63]
s_or_b64 vcc, vcc, s[40:41]
s_cbranch_scc0 F_in
s_mov_b64 exec, s[24:25]
buffer_load_dwordx4 v[64:67], v2, s[48:51], s60 offen offset:0 sc0 sc1
s_mov_b64 exec, s[26:27]
buffer_load_dwordx4 v[68:71], v2, s[48:51], s60 offen offset:1024 sc0 sc1
s_mov_b64 exec, s[28:29]
buffer_load_dwordx4 v[72:75], v2, s[48:51], s60 offen offset:2048 sc0 sc1
s_mov_b64 exec, s[30:31]
buffer_load_dwordx4 v[76:79], v2, s[48:51], s60 offen offset:3072 sc0 sc1
s_mov_b64 exec, s[32:33]
buffer_load_dwordx4 v[80:83], v2, s[48:51], s61 offen offset:0 sc0 sc1
s_mov_b64 exec, s[34:35]
buffer_load_dwordx4 v[84:87], v2, s[48:51], s61 offen offset:1024 sc0 sc1
s_mov_b64 exec, s[36:37]
buffer_load_dwordx4 v[88:91], v2, s[48:51], s61 offen offset:2048 sc0 sc1
s_mov_b64 exec, s[40:41]
buffer_load_dwordx4 v[92:95], v2, s[48:51], s61 offen offset:3072 sc0 sc1
s_mov_b64 exec, s[42:43]
buffer_load_dwordx4 v[96:99], v2, s[48:51], s62 offen sc0 sc1
s_mov_b64 exec, -1
s_sub_u32 s15, s15, 16
s_cbranch_scc0 F_loop
F_in:
v_cmp_ne_u32 vcc, 0, v98
s_cbranch_vccnz F_slow
F_in2:
F_wr:
v_add_f32 v56, v56, v57
v_add_f32 v57, v58, v59
s_nop 0
v_add_f32_dpp v56, v56, v56 quad_perm:[2,3,0,1] row_mask:0xf bank_mask:0xf
v_add_f32_dpp v57, v57, v57 quad_perm:[2,3,0,1] row_mask:0xf bank_mask:0xf
s_nop 0
v_add_f32_dpp v56, v56, v56 row_ror:4 row_mask:0xf bank_mask:0xf
v_add_f32_dpp v57, v57, v57 row_ror:4 row_mask:0xf bank_mask:0xf
s_nop 0
v_add_f32_dpp v56, v56, v56 row_ror:8 row_mask:0xf bank_mask:0xf
v_add_f32_dpp v57, v57, v57 row_ror:8 row_mask:0xf bank_mask:0xf
v_add_f32 v16, v16, v60
v_add_f32 v17, v17, v61
v_add_f32 v18, v18, v62
v_add_f32 v19, v19, v63
s_and_b64 exec, s[52:53], 0xffff
ds_write_b128 v9, v[16:19]
s_lshl_b32 exec_lo, exec_lo, 16
ds_write_b64 v9, v[16:17]
F_red:
s_and_b64 exec, s[52:53], 3
ds_write_b64 v11, v[56:57] offset:384
s_and_b64 exec, s[52:53], 1
ds_add_u32 v3, v7 offset:124
s_mov_b64 exec, -1
s_cmp_ge_u32 s3, 6
s_cbranch_scc1 F_e0
Lpoll_38:
ds_read_b32 v4, v3 offset:124
s_waitcnt lgkmcnt(0)
v_readfirstlane_b32 s57, v4
s_sub_u32 s15, s15, 1
s_cselect_b32 s57, s12, s57
s_cmp_lt_u32 s57, s12
s_cbranch_scc1 Lpoll_38
ds_read_b32 v56, v49
ds_read_b32 v57, v49 offset:1664
ds_read_b128 v[100:103], v5 offset:0
ds_read_b128 v[104:107], v5 offset:16
ds_read_b128 v[108:111], v5 offset:128
ds_read_b128 v[112:115], v5 offset:144
ds_read_b128 v[116:119], v5 offset:256
ds_read_b128 v[120:123], v5 offset:272
ds_read_b64_tr_b16 v[24:25], v50 offset:0
ds_read_b64_tr_b16 v[26:27], v50 offset:768
ds_read_b64_tr_b16 v[28:29], v50 offset:6144
ds_read_b64_tr_b16 v[30:31], v50 offset:6912
ds_read_b64_tr_b16 v[32:33], v50 offset:12288
ds_read_b64_tr_b16 v[34:35], v50 offset:13056
s_waitcnt lgkmcnt(12)
v_add_f32 v56, v56, v57
s_nop 1
v_mfma_f32_16x16x4_f32 v[16:19], v56, v53, 0
s_nop 11
v_rcp_f32 v16, v16
v_rcp_f32 v17, v17
v_rcp_f32 v18, v18
v_rcp_f32 v19, v19
v_cndmask_b32 v20, v16, v17, s[18:19]
v_cndmask_b32 v21, v17, v18, s[10:11]
v_cndmask_b32 v22, v18, v19, s[20:21]
s_waitcnt lgkmcnt(0)
v_pk_mul_f32 v[100:101], v[100:101], v[20:21] op_sel:[0,0] op_sel_hi:[1,0]
v_pk_mul_f32 v[102:103], v[102:103], v[20:21] op_sel:[0,0] op_sel_hi:[1,0]
v_pk_mul_f32 v[104:105], v[104:105], v[20:21] op_sel:[0,0] op_sel_hi:[1,0]
v_pk_mul_f32 v[106:107], v[106:107], v[20:21] op_sel:[0,0] op_sel_hi:[1,0]
v_cvt_pk_bf16_f32 v36, v100, v101
v_cvt_pk_bf16_f32 v37, v102, v103
v_cvt_pk_bf16_f32 v38, v104, v105
v_cvt_pk_bf16_f32 v39, v106, v107
s_nop 1
v_mfma_f32_16x16x32_bf16 v[56:59], v[36:39], v[24:27], 0
v_pk_mul_f32 v[108:109], v[108:109], v[20:21] op_sel:[0,1] op_sel_hi:[1,1]
v_pk_mul_f32 v[110:111], v[110:111], v[20:21] op_sel:[0,1] op_sel_hi:[1,1]
v_pk_mul_f32 v[112:113], v[112:113], v[20:21] op_sel:[0,1] op_sel_hi:[1,1]
v_pk_mul_f32 v[114:115], v[114:115], v[20:21] op_sel:[0,1] op_sel_hi:[1,1]
v_cvt_pk_bf16_f32 v40, v108, v109
v_cvt_pk_bf16_f32 v41, v110, v111
v_cvt_pk_bf16_f32 v42, v112, v113
v_cvt_pk_bf16_f32 v43, v114, v115
s_nop 1
v_mfma_f32_16x16x32_bf16 v[56:59], v[40:43], v[28:31], v[56:59]
v_pk_mul_f32 v[116:117], v[116:117], v[22:23] op_sel:[0,0] op_sel_hi:[1,0]
v_pk_mul_f32 v[118:119], v[118:119], v[22:23] op_sel:[0,0] op_sel_hi:[1,0]
v_pk_mul_f32 v[120:121], v[120:121], v[22:23] op_sel:[0,0] op_sel_hi:[1,0]
v_pk_mul_f32 v[122:123], v[122:123], v[22:23] op_sel:[0,0] op_sel_hi:[1,0]
v_cvt_pk_bf16_f32 v44, v116, v117
v_cvt_pk_bf16_f32 v45, v118, v119
v_cvt_pk_bf16_f32 v46, v120, v121
v_cvt_pk_bf16_f32 v47, v122, v123
s_nop 1
v_mfma_f32_16x16x32_bf16 v[56:59], v[44:47], v[32:35], v[56:59]
s_nop 7
v_add_f32 v56, v56, v57
v_add_f32 v58, v58, v59
v_add_f32 v56, v56, v58
v_mov_b32 v57, v56
s_nop 1
v_permlane16_swap_b32 v56, v57
v_add_f32 v56, v56, v57
s_mov_b64 exec, s[16:17]
v_cvt_pk_bf16_f32 v56, v56, v56
v_and_b32 v56, s9, v56
v_add_f32 v56, v56, v52
v_cvt_pk_bf16_f32 v56, v56, v56
buffer_store_short v56, v6, s[44:47], s7 offen
F_e0:
s_cmp_eq_u32 s12, 0
s_cbranch_scc1 F_back
s_or_b32 s12, s2, s3
s_cmp_lg_u32 s12, 0
s_cbranch_scc1 F_end
s_mov_b32 s12, 1179648
v_mov_b32 v4, s14
v_mov_b32 v5, 0
s_mov_b64 exec, 1
buffer_store_dword v4, v5, s[48:51], s12 offen sc0 sc1
F_end:
s_mov_b64 exec, -1
s_endpgm
F_slow:
v_bfe_u32 v4, v1, 3, 1
v_lshl_add_u32 v4, v8, 1, v4
v_lshlrev_b32 v4, 2, v4
ds_bpermute_b32 v100, v4, v98 offset:0
ds_bpermute_b32 v102, v4, v98 offset:32
ds_bpermute_b32 v104, v4, v98 offset:64
ds_bpermute_b32 v106, v4, v98 offset:96
ds_bpermute_b32 v108, v4, v98 offset:128
ds_bpermute_b32 v110, v4, v98 offset:160
ds_bpermute_b32 v112, v4, v98 offset:192
ds_bpermute_b32 v114, v4, v98 offset:224
v_mov_b32 v116, 0xff800000
v_mov_b32 v56, 163344
s_mov_b64 exec, 15
v_lshl_add_u32 v56, v1, 2, v56
s_cmp_lg_u32 s3, 0
s_cbranch_scc1 F_s1
ds_write_b32 v56, v116
F_s1:
s_mov_b64 exec, -1
s_mov_b64 exec, 1
ds_add_u32 v3, v7 offset:128
s_mov_b64 exec, -1
v_lshlrev_b32 v118, 16, v98
v_and_b32 v119, s9, v98
v_and_b32 v56, 1, v1
v_lshlrev_b32 v56, 3, v56
v_add_u32 v56, 163344, v56
Lpoll_41:
ds_read_b32 v4, v3 offset:128
s_waitcnt lgkmcnt(0)
v_readfirstlane_b32 s57, v4
s_sub_u32 s15, s15, 1
s_cselect_b32 s57, 8, s57
s_cmp_ge_u32 s57, 8
s_cbranch_scc1 Lpd_42
s_sleep 1
s_branch Lpoll_41
Lpd_42:
ds_max_f32 v56, v118
ds_max_f32 v56, v119 offset:4
s_mov_b64 exec, 1
ds_add_u32 v3, v7 offset:128
s_mov_b64 exec, -1
Lpoll_44:
ds_read_b32 v4, v3 offset:128
s_waitcnt lgkmcnt(0)
v_readfirstlane_b32 s57, v4
s_sub_u32 s15, s15, 1
s_cselect_b32 s57, 16, s57
s_cmp_ge_u32 s57, 16
s_cbranch_scc1 Lpd_45
s_sleep 1
s_branch Lpoll_44
Lpd_45:
ds_read_b64 v[116:117], v56
v_bfe_u32 v57, v1, 3, 1
v_lshlrev_b32 v57, 3, v57
v_add_u32 v57, 163344, v57
ds_read_b64 v[58:59], v57
s_waitcnt lgkmcnt(0)
v_sub_f32 v118, v118, v116
v_sub_f32 v119, v119, v117
v_exp_f32 v118, v118
v_exp_f32 v119, v119
v_mov_b32 v116, v58
v_mov_b32 v117, v59
v_lshlrev_b32 v56, 16, v96
v_and_b32 v36, s9, v96
v_add_f32 v56, v56, v36
v_mul_f32 v56, v56, v118
s_nop 1
v_add_f32_dpp v56, v56, v56 quad_perm:[2,3,0,1] row_mask:0xf bank_mask:0xf
s_nop 1
v_add_f32_dpp v56, v56, v56 row_ror:4 row_mask:0xf bank_mask:0xf
s_nop 1
v_add_f32_dpp v56, v56, v56 row_ror:8 row_mask:0xf bank_mask:0xf
v_mov_b32 v4, v56
s_nop 1
v_permlane32_swap_b32 v56, v4
v_add_f32 v56, v56, v4
v_mov_b32 v4, v56
s_nop 1
v_permlane16_swap_b32 v56, v4
v_add_f32 v56, v56, v4
v_lshlrev_b32 v57, 16, v97
v_and_b32 v36, s9, v97
v_add_f32 v57, v57, v36
v_mul_f32 v57, v57, v119
s_nop 1
v_add_f32_dpp v57, v57, v57 quad_perm:[2,3,0,1] row_mask:0xf bank_mask:0xf
s_nop 1
v_add_f32_dpp v57, v57, v57 row_ror:4 row_mask:0xf bank_mask:0xf
s_nop 1
v_add_f32_dpp v57, v57, v57 row_ror:8 row_mask:0xf bank_mask:0xf
v_mov_b32 v4, v57
s_nop 1
v_permlane32_swap_b32 v57, v4
v_add_f32 v57, v57, v4
v_mov_b32 v4, v57
s_nop 1
v_permlane16_swap_b32 v57, v4
v_add_f32 v57, v57, v4
v_bfe_u32 v4, v1, 2, 1
v_cmp_eq_u32 s[22:23], 1, v4
v_bfe_u32 v4, v1, 1, 1
v_cmp_eq_u32 s[24:25], 1, v4
v_mov_b32 v120, 0
v_mov_b32 v121, 0
v_mov_b32 v122, 0
v_mov_b32 v123, 0
v_mov_b32 v124, 0
v_mov_b32 v125, 0
v_mov_b32 v126, 0
v_mov_b32 v127, 0
v_and_b32 v101, s9, v100
v_lshlrev_b32 v100, 16, v100
v_sub_f32 v100, v100, v116
v_sub_f32 v101, v101, v117
v_exp_f32 v100, v100
v_exp_f32 v101, v101
s_nop 0
v_cndmask_b32 v4, v100, v101, s[22:23]
v_lshlrev_b32 v36, 16, v64
v_and_b32 v37, s9, v64
v_fmac_f32 v120, v36, v4
v_fmac_f32 v121, v37, v4
v_cndmask_b32 v4, v100, v101, s[22:23]
v_lshlrev_b32 v36, 16, v65
v_and_b32 v37, s9, v65
v_fmac_f32 v122, v36, v4
v_fmac_f32 v123, v37, v4
v_cndmask_b32 v4, v100, v101, s[24:25]
v_lshlrev_b32 v36, 16, v66
v_and_b32 v37, s9, v66
v_fmac_f32 v124, v36, v4
v_fmac_f32 v125, v37, v4
v_and_b32 v103, s9, v102
v_lshlrev_b32 v102, 16, v102
v_sub_f32 v102, v102, v116
v_sub_f32 v103, v103, v117
v_exp_f32 v102, v102
v_exp_f32 v103, v103
s_nop 0
v_cndmask_b32 v4, v102, v103, s[22:23]
v_lshlrev_b32 v36, 16, v68
v_and_b32 v37, s9, v68
v_fmac_f32 v120, v36, v4
v_fmac_f32 v121, v37, v4
v_cndmask_b32 v4, v102, v103, s[22:23]
v_lshlrev_b32 v36, 16, v69
v_and_b32 v37, s9, v69
v_fmac_f32 v122, v36, v4
v_fmac_f32 v123, v37, v4
v_cndmask_b32 v4, v102, v103, s[24:25]
v_lshlrev_b32 v36, 16, v70
v_and_b32 v37, s9, v70
v_fmac_f32 v124, v36, v4
v_fmac_f32 v125, v37, v4
v_and_b32 v105, s9, v104
v_lshlrev_b32 v104, 16, v104
v_sub_f32 v104, v104, v116
v_sub_f32 v105, v105, v117
v_exp_f32 v104, v104
v_exp_f32 v105, v105
s_nop 0
v_cndmask_b32 v4, v104, v105, s[22:23]
v_lshlrev_b32 v36, 16, v72
v_and_b32 v37, s9, v72
v_fmac_f32 v120, v36, v4
v_fmac_f32 v121, v37, v4
v_cndmask_b32 v4, v104, v105, s[22:23]
v_lshlrev_b32 v36, 16, v73
v_and_b32 v37, s9, v73
v_fmac_f32 v122, v36, v4
v_fmac_f32 v123, v37, v4
v_cndmask_b32 v4, v104, v105, s[24:25]
v_lshlrev_b32 v36, 16, v74
v_and_b32 v37, s9, v74
v_fmac_f32 v124, v36, v4
v_fmac_f32 v125, v37, v4
v_and_b32 v107, s9, v106
v_lshlrev_b32 v106, 16, v106
v_sub_f32 v106, v106, v116
v_sub_f32 v107, v107, v117
v_exp_f32 v106, v106
v_exp_f32 v107, v107
s_nop 0
v_cndmask_b32 v4, v106, v107, s[22:23]
v_lshlrev_b32 v36, 16, v76
v_and_b32 v37, s9, v76
v_fmac_f32 v120, v36, v4
v_fmac_f32 v121, v37, v4
v_cndmask_b32 v4, v106, v107, s[22:23]
v_lshlrev_b32 v36, 16, v77
v_and_b32 v37, s9, v77
v_fmac_f32 v122, v36, v4
v_fmac_f32 v123, v37, v4
v_cndmask_b32 v4, v106, v107, s[24:25]
v_lshlrev_b32 v36, 16, v78
v_and_b32 v37, s9, v78
v_fmac_f32 v124, v36, v4
v_fmac_f32 v125, v37, v4
v_and_b32 v109, s9, v108
v_lshlrev_b32 v108, 16, v108
v_sub_f32 v108, v108, v116
v_sub_f32 v109, v109, v117
v_exp_f32 v108, v108
v_exp_f32 v109, v109
s_nop 0
v_cndmask_b32 v4, v108, v109, s[22:23]
v_lshlrev_b32 v36, 16, v80
v_and_b32 v37, s9, v80
v_fmac_f32 v120, v36, v4
v_fmac_f32 v121, v37, v4
v_cndmask_b32 v4, v108, v109, s[22:23]
v_lshlrev_b32 v36, 16, v81
v_and_b32 v37, s9, v81
v_fmac_f32 v122, v36, v4
v_fmac_f32 v123, v37, v4
v_cndmask_b32 v4, v108, v109, s[24:25]
v_lshlrev_b32 v36, 16, v82
v_and_b32 v37, s9, v82
v_fmac_f32 v124, v36, v4
v_fmac_f32 v125, v37, v4
v_and_b32 v111, s9, v110
v_lshlrev_b32 v110, 16, v110
v_sub_f32 v110, v110, v116
v_sub_f32 v111, v111, v117
v_exp_f32 v110, v110
v_exp_f32 v111, v111
s_nop 0
v_cndmask_b32 v4, v110, v111, s[22:23]
v_lshlrev_b32 v36, 16, v84
v_and_b32 v37, s9, v84
v_fmac_f32 v120, v36, v4
v_fmac_f32 v121, v37, v4
v_cndmask_b32 v4, v110, v111, s[22:23]
v_lshlrev_b32 v36, 16, v85
v_and_b32 v37, s9, v85
v_fmac_f32 v122, v36, v4
v_fmac_f32 v123, v37, v4
v_cndmask_b32 v4, v110, v111, s[24:25]
v_lshlrev_b32 v36, 16, v86
v_and_b32 v37, s9, v86
v_fmac_f32 v124, v36, v4
v_fmac_f32 v125, v37, v4
v_and_b32 v113, s9, v112
v_lshlrev_b32 v112, 16, v112
v_sub_f32 v112, v112, v116
v_sub_f32 v113, v113, v117
v_exp_f32 v112, v112
v_exp_f32 v113, v113
s_nop 0
v_cndmask_b32 v4, v112, v113, s[22:23]
v_lshlrev_b32 v36, 16, v88
v_and_b32 v37, s9, v88
v_fmac_f32 v120, v36, v4
v_fmac_f32 v121, v37, v4
v_cndmask_b32 v4, v112, v113, s[22:23]
v_lshlrev_b32 v36, 16, v89
v_and_b32 v37, s9, v89
v_fmac_f32 v122, v36, v4
v_fmac_f32 v123, v37, v4
v_cndmask_b32 v4, v112, v113, s[24:25]
v_lshlrev_b32 v36, 16, v90
v_and_b32 v37, s9, v90
v_fmac_f32 v124, v36, v4
v_fmac_f32 v125, v37, v4
v_and_b32 v115, s9, v114
v_lshlrev_b32 v114, 16, v114
v_sub_f32 v114, v114, v116
v_sub_f32 v115, v115, v117
v_exp_f32 v114, v114
v_exp_f32 v115, v115
s_nop 0
v_cndmask_b32 v4, v114, v115, s[22:23]
v_lshlrev_b32 v36, 16, v92
v_and_b32 v37, s9, v92
v_fmac_f32 v120, v36, v4
v_fmac_f32 v121, v37, v4
v_cndmask_b32 v4, v114, v115, s[22:23]
v_lshlrev_b32 v36, 16, v93
v_and_b32 v37, s9, v93
v_fmac_f32 v122, v36, v4
v_fmac_f32 v123, v37, v4
v_cndmask_b32 v4, v114, v115, s[24:25]
v_lshlrev_b32 v36, 16, v94
v_and_b32 v37, s9, v94
v_fmac_f32 v124, v36, v4
v_fmac_f32 v125, v37, v4
v_mov_b32 v4, v120
s_nop 1
v_permlane32_swap_b32 v120, v4
v_add_f32 v120, v120, v4
v_mov_b32 v4, v120
s_nop 1
v_permlane16_swap_b32 v120, v4
v_add_f32 v120, v120, v4
v_mov_b32 v4, v121
s_nop 1
v_permlane32_swap_b32 v121, v4
v_add_f32 v121, v121, v4
v_mov_b32 v4, v121
s_nop 1
v_permlane16_swap_b32 v121, v4
v_add_f32 v121, v121, v4
v_mov_b32 v4, v122
s_nop 1
v_permlane32_swap_b32 v122, v4
v_add_f32 v122, v122, v4
v_mov_b32 v4, v122
s_nop 1
v_permlane16_swap_b32 v122, v4
v_add_f32 v122, v122, v4
v_mov_b32 v4, v123
s_nop 1
v_permlane32_swap_b32 v123, v4
v_add_f32 v123, v123, v4
v_mov_b32 v4, v123
s_nop 1
v_permlane16_swap_b32 v123, v4
v_add_f32 v123, v123, v4
v_mov_b32 v4, v124
s_nop 1
v_permlane32_swap_b32 v124, v4
v_add_f32 v124, v124, v4
v_mov_b32 v4, v124
s_nop 1
v_permlane16_swap_b32 v124, v4
v_add_f32 v124, v124, v4
v_mov_b32 v4, v125
s_nop 1
v_permlane32_swap_b32 v125, v4
v_add_f32 v125, v125, v4
v_mov_b32 v4, v125
s_nop 1
v_permlane16_swap_b32 v125, v4
v_add_f32 v125, v125, v4
s_mov_b64 exec, 0xffff
ds_write_b128 v9, v[120:123]
s_mov_b32 exec_lo, 0xffff0000
ds_write_b64 v9, v[124:125]
s_mov_b64 exec, -1
s_branch F_red
L_att:
s_sub_u32 s44, s3, 8
s_lshr_b32 s45, s44, 1
s_and_b32 s46, s44, 1
v_lshlrev_b32 v158, 4, v1
s_setprio 3
v_and_b32 v0, 15, v1
v_lshrrev_b32 v160, 4, v1
v_add_u32 v152, 0, v1
v_mul_u32_u24 v153, 43691, v152
v_lshrrev_b32 v153, 17, v153
v_mul_u32_u24 v153, 144, v153
v_add_u32 v153, v153, v158
v_add_u32 v152, 64, v1
v_mul_u32_u24 v154, 43691, v152
v_lshrrev_b32 v154, 17, v154
v_mul_u32_u24 v154, 144, v154
v_add_u32 v154, v154, v158
v_add_u32 v152, 128, v1
v_mul_u32_u24 v155, 43691, v152
v_lshrrev_b32 v155, 17, v155
v_mul_u32_u24 v155, 144, v155
v_add_u32 v155, v155, v158
s_waitcnt lgkmcnt(0)
s_add_u32 s12, s38, 1179648
s_addc_u32 s13, s39, 0
s_load_dword s14, s[12:13], 0
v_mov_b32 v156, 156688
v_mov_b32 v157, 1
v_mul_u32_u24 v144, 192, v0
s_cmp_lg_u32 s44, 0
s_cbranch_scc1 L_47
s_mov_b32 s40, s16
s_mov_b32 s41, s17
s_mov_b32 s42, 3072
s_mov_b32 s43, 0x20000
v_lshl_add_u32 v152, v160, 4, v144
buffer_load_dwordx4 v[16:19], v152, s[40:43], 0 offen offset:0
buffer_load_dwordx4 v[20:23], v152, s[40:43], 0 offen offset:64
buffer_load_dwordx4 v[24:27], v152, s[40:43], 0 offen offset:128
s_bfe_u32 s51, s2, 0x20005
s_bfe_u32 s52, s2, 0x20003
s_mul_i32 s53, s51, 4608
s_mov_b32 s40, s24
s_mov_b32 s41, s25
s_mov_b32 s42, 18432
s_mov_b32 s43, 0x20000
s_mov_b32 m0, 129024
s_add_u32 s47, s53, 4096
buffer_load_dwordx4 v158, s[40:43], s53 offen offset:0 lds
buffer_load_dwordx4 v158, s[40:43], s53 offen offset:1024 lds
buffer_load_dwordx4 v158, s[40:43], s53 offen offset:2048 lds
buffer_load_dwordx4 v158, s[40:43], s53 offen offset:3072 lds
s_mov_b32 m0, 133120
s_mov_b32 exec_hi, 0
buffer_load_dwordx4 v158, s[40:43], s47 offen lds
s_mov_b32 exec_hi, -1
s_mov_b32 s40, s32
s_mov_b32 s41, s33
s_mov_b32 s42, 18432
s_mov_b32 s43, 0x20000
s_mul_i32 s47, s52, 48
s_mov_b32 m0, 133632
s_add_u32 s48, s47, 9216
buffer_load_dwordx4 v153, s[40:43], s47 offen offset:0 lds
buffer_load_dwordx4 v154, s[40:43], s47 offen offset:1024 lds
buffer_load_dwordx4 v155, s[40:43], s47 offen offset:2048 lds
buffer_load_dwordx4 v153, s[40:43], s48 offen offset:3072 lds
s_mov_b32 m0, 137728
s_add_u32 s48, s47, 13312
s_mov_b32 exec_hi, 0
buffer_load_dwordx4 v154, s[40:43], s48 offen lds
s_mov_b32 exec_hi, -1
s_mov_b32 s40, s26
s_mov_b32 s41, s27
s_mov_b32 s42, 18432
s_mov_b32 s43, 0x20000
v_min_u32 v152, 2, v160
v_lshlrev_b32 v152, 4, v152
v_mad_u32_u24 v153, v0, 48, v152
v_and_b32 v154, 7, v1
v_mad_u32_u24 v154, v154, 48, v152
s_mul_i32 s47, s52, 1152
s_add_u32 s47, s47, s53
buffer_load_dwordx4 v[40:43], v153, s[40:43], s47 offen
buffer_load_dwordx4 v[44:47], v154, s[40:43], s47 offen offset:768
v_lshl_add_u32 v153, v1, 2, v156
v_cmp_eq_u32 vcc, 20, v1
s_nop 1
v_cndmask_b32 v154, 0, -2, vcc
ds_write_b32 v153, v154
s_waitcnt lgkmcnt(0)
L_47:
s_barrier
s_mul_i32 s55, s46, 12288
s_mul_i32 s63, s46, 9216
s_sub_u32 s63, 24576, s63
s_mov_b32 s62, 24576
s_mul_i32 s60, s45, 9216
s_add_u32 s60, s60, 110592
s_mul_i32 s61, s44, 4608
s_add_u32 s61, s61, 110592
v_lshrrev_b32 v161, 5, v1
v_bfe_u32 v162, v1, 4, 1
v_bfe_u32 v163, v1, 2, 2
v_and_b32 v164, 3, v1
v_lshl_add_u32 v153, v160, 3, v163
v_mul_u32_u24 v153, 48, v153
v_min_u32 v154, 2, v164
v_lshl_add_u32 v145, v154, 4, v153
v_add_u32 v145, 129024, v145
v_add_u32 v153, 133632, v153
v_lshl_add_u32 v146, v164, 3, v153
v_and_b32 v154, 1, v1
v_lshl_add_u32 v147, v154, 3, v153
v_cmp_gt_u32 vcc, 3, v160
s_nop 1
v_cndmask_b32 v150, 0, 2.0, vcc
v_mul_u32_u24 v144, 208, v0
v_add_u32 v153, s61, v144
v_lshl_add_u32 v148, v160, 3, v153
v_lshl_add_u32 v153, v162, 3, v153
v_lshl_add_u32 v151, v161, 2, v153
v_mul_u32_u24 v154, 4608, v162
v_add3_u32 v149, v144, v154, s60
v_lshl_add_u32 v149, v161, 4, v149
v_cmp_eq_u32 vcc, v0, v162
v_mov_b32 v154, 0x3f803f80
s_nop 0
v_cndmask_b32 v8, 0, v154, vcc
v_mov_b32 v12, 0
v_mov_b32 v13, 0
v_mov_b32 v14, 0
v_mov_b32 v15, 0
v_mov_b32 v9, v8
v_mov_b32 v10, v8
v_mov_b32 v11, v8
v_lshl_add_u32 v3, v1, 1, s46
v_min_u32 v3, 20, v3
v_lshl_add_u32 v3, v3, 2, v156
v_mul_u32_u24 v154, 6144, v162
v_add_u32 v154, s55, v154
v_lshlrev_b32 v155, 2, v161
v_xor_b32 v155, v155, v0
v_lshl_add_u32 v4, v161, 4, v155
v_lshl_add_u32 v4, v4, 4, v154
v_xor_b32 v155, 10, v155
v_lshl_add_u32 v5, v161, 4, v155
v_add_u32 v5, 32, v5
v_lshl_add_u32 v5, v5, 4, v154
v_bfe_u32 v152, v1, 1, 1
v_lshl_add_u32 v154, v162, 1, v152
v_lshl_add_u32 v153, v161, 2, v163
v_lshlrev_b32 v7, 1, v162
v_lshl_add_u32 v7, v154, 2, v7
v_xor_b32 v155, v153, v7
v_lshl_add_u32 v155, v154, 4, v155
v_lshlrev_b32 v155, 4, v155
v_and_b32 v7, 1, v1
v_lshl_add_u32 v155, v7, 3, v155
v_add_u32 v6, s55, v155
v_xor_b32 v7, 128, v6
v_mul_u32_u24 v154, 48, v153
v_lshl_add_u32 v154, v164, 3, v154
v_add_u32 v2, s60, v154
v_cmp_eq_u32 s[18:19], 0, v162
v_cmp_le_u32 s[20:21], 2, v164
v_cmp_eq_u32 s[22:23], v152, v162
v_add_u32 v153, 32, v2
v_add_u32 v154, 4592, v2
v_mov_b32 v155, 156944
v_cndmask_b32 v0, v153, v154, s[20:21]
v_cndmask_b32 v0, v155, v0, s[22:23]
s_mov_b32 s40, s38
s_mov_b32 s41, s39
s_mov_b32 s42, 2097152
s_mov_b32 s43, 0x20000
s_waitcnt lgkmcnt(0)
s_add_u32 s14, s14, 0x9e3779b9
s_and_b32 s14, s14, 0xbfffbfff
s_and_b32 s57, s2, 7
s_lshl_b32 s57, s57, 14
s_add_u32 s57, s57, 1183744
s_cmp_lg_u32 s44, 0
s_cbranch_scc1 L_48
s_lshl_b32 s47, s51, 2
s_add_u32 s47, s47, s52
s_lshl_b32 s47, s47, 10
s_add_u32 s58, s57, s47
s_mov_b32 s34, 0x3e16c740
v_mov_b32 v115, s14
v_cmp_gt_u32 vcc, 32, v1
s_waitcnt vmcnt(7)
ds_read_b64_tr_b16 v[120:121], v145 offset:0
ds_read_b64_tr_b16 v[122:123], v145 offset:192
ds_read_b64_tr_b16 v[124:125], v145 offset:8
ds_read_b64_tr_b16 v[126:127], v145 offset:200
ds_read_b64_tr_b16 v[128:129], v145 offset:1536
ds_read_b64_tr_b16 v[130:131], v145 offset:1728
ds_read_b64_tr_b16 v[132:133], v145 offset:1544
ds_read_b64_tr_b16 v[134:135], v145 offset:1736
ds_read_b64_tr_b16 v[136:137], v145 offset:3072
ds_read_b64_tr_b16 v[138:139], v145 offset:3264
ds_read_b64_tr_b16 v[140:141], v145 offset:3080
ds_read_b64_tr_b16 v[142:143], v145 offset:3272
s_waitcnt lgkmcnt(10)
v_mfma_f32_16x16x32_bf16 v[32:35], v[120:123], v[16:19], 0
s_waitcnt lgkmcnt(8)
v_mfma_f32_16x16x32_bf16 v[36:39], v[124:127], v[16:19], 0
s_waitcnt lgkmcnt(6)
v_mfma_f32_16x16x32_bf16 v[32:35], v[128:131], v[20:23], v[32:35]
s_waitcnt lgkmcnt(4)
v_mfma_f32_16x16x32_bf16 v[36:39], v[132:135], v[20:23], v[36:39]
s_waitcnt lgkmcnt(2)
v_mfma_f32_16x16x32_bf16 v[32:35], v[136:139], v[24:27], v[32:35]
s_waitcnt lgkmcnt(0)
v_mfma_f32_16x16x32_bf16 v[36:39], v[140:143], v[24:27], v[36:39]
s_waitcnt vmcnt(2)
ds_read_b64_tr_b16 v[88:89], v146 offset:0
ds_read_b64_tr_b16 v[90:91], v146 offset:192
ds_read_b64_tr_b16 v[92:93], v147 offset:32
ds_read_b64_tr_b16 v[94:95], v147 offset:224
ds_read_b64_tr_b16 v[96:97], v146 offset:1536
ds_read_b64_tr_b16 v[98:99], v146 offset:1728
ds_read_b64_tr_b16 v[100:101], v147 offset:1568
ds_read_b64_tr_b16 v[102:103], v147 offset:1760
ds_read_b64_tr_b16 v[104:105], v146 offset:3072
ds_read_b64_tr_b16 v[106:107], v146 offset:3264
ds_read_b64_tr_b16 v[108:109], v147 offset:3104
ds_read_b64_tr_b16 v[110:111], v147 offset:3296
v_mul_f32 v32, v150, v32
v_mul_f32 v33, v150, v33
v_cvt_pk_bf16_f32 v28, v32, v33
v_mul_f32 v34, v150, v34
v_mul_f32 v35, v150, v35
v_cvt_pk_bf16_f32 v29, v34, v35
v_mul_f32 v36, v150, v36
v_mul_f32 v37, v150, v37
v_cvt_pk_bf16_f32 v30, v36, v37
v_mul_f32 v38, v150, v38
v_mul_f32 v39, v150, v39
v_cvt_pk_bf16_f32 v31, v38, v39
s_waitcnt lgkmcnt(10)
v_mfma_f32_16x16x32_bf16 v[48:51], v[88:91], v[16:19], 0
s_waitcnt lgkmcnt(8)
v_mfma_f32_16x16x32_bf16 v[52:55], v[92:95], v[16:19], 0
s_waitcnt lgkmcnt(6)
v_mfma_f32_16x16x32_bf16 v[48:51], v[96:99], v[20:23], v[48:51]
s_waitcnt lgkmcnt(4)
v_mfma_f32_16x16x32_bf16 v[52:55], v[100:103], v[20:23], v[52:55]
s_waitcnt lgkmcnt(2)
v_mfma_f32_16x16x32_bf16 v[48:51], v[104:107], v[24:27], v[48:51]
s_waitcnt lgkmcnt(0)
v_mfma_f32_16x16x32_bf16 v[52:55], v[108:111], v[24:27], v[52:55]
s_waitcnt vmcnt(0)
v_mfma_f32_16x16x32_bf16 v[48:51], v[40:43], v[28:31], v[48:51]
v_mfma_f32_16x16x32_bf16 v[52:55], v[44:47], v[28:31], v[52:55]
s_nop 6
v_mul_f32 v48, s34, v48
v_mul_f32 v49, s34, v49
v_mul_f32 v50, s34, v50
v_mul_f32 v51, s34, v51
v_cndmask_b32 v52, v54, v52, vcc
v_cndmask_b32 v53, v55, v53, vcc
v_cvt_pk_bf16_f32 v112, v48, v49
v_cvt_pk_bf16_f32 v113, v50, v51
v_mul_f32 v52, s34, v52
v_mul_f32 v53, s34, v53
v_cvt_pk_bf16_f32 v114, v52, v53
buffer_store_dwordx4 v[112:115], v158, s[40:43], s58 offen sc0 sc1
s_mov_b64 exec, 1
ds_add_u32 v156, v157 offset:156
s_mov_b64 exec, -1
Lpoll_49:
ds_read_b32 v165, v156 offset:160
s_waitcnt lgkmcnt(0)
v_readfirstlane_b32 s47, v165
s_sub_u32 s15, s15, 1
s_cselect_b32 s47, 1, s47
s_cmp_ge_u32 s47, 1
s_cbranch_scc1 Lpd_50
s_sleep 1
s_branch Lpoll_49
Lpd_50:
s_mov_b64 exec, 1
ds_add_u32 v156, v157 offset:156
s_mov_b64 exec, -1
L_48:
v_mfma_f32_32x32x16_bf16 v[40:55], v[12:15], v[12:15], 0
v_mfma_f32_32x32x16_bf16 v[56:71], v[12:15], v[12:15], 0
v_mfma_f32_32x32x16_bf16 v[72:87], v[12:15], v[12:15], 0
s_lshl_b32 s47, s44, 12
s_add_u32 s57, s57, s47
Lpoll_52:
ds_read_b32 v165, v156 offset:156
s_waitcnt lgkmcnt(0)
v_readfirstlane_b32 s47, v165
s_sub_u32 s15, s15, 1
s_cselect_b32 s47, 2, s47
s_cmp_ge_u32 s47, 2
s_cbranch_scc1 Lpd_53
s_sleep 1
s_branch Lpoll_52
Lpd_53:
buffer_load_dwordx4 v[88:91], v158, s[40:43], s57 offen offset:0 sc1
buffer_load_dwordx4 v[92:95], v158, s[40:43], s57 offen offset:1024 sc1
buffer_load_dwordx4 v[96:99], v158, s[40:43], s57 offen offset:2048 sc1
buffer_load_dwordx4 v[100:103], v158, s[40:43], s57 offen offset:3072 sc1
s_mov_b64 exec, 1
ds_add_u32 v156, v157 offset:152
s_mov_b64 exec, -1
v_lshl_add_u32 v154, s45, 2, v156
Lapc_55:
s_waitcnt vmcnt(0)
v_cmp_ne_u32 vcc, s14, v91
v_cmp_ne_u32 s[24:25], s14, v95
v_cmp_ne_u32 s[26:27], s14, v99
v_cmp_ne_u32 s[28:29], s14, v103
s_or_b64 vcc, vcc, s[24:25]
s_or_b64 s[26:27], s[26:27], s[28:29]
s_or_b64 vcc, vcc, s[26:27]
s_cbranch_scc0 Lapo_56
buffer_load_dwordx4 v[88:91], v158, s[40:43], s57 offen offset:0 sc0 sc1
buffer_load_dwordx4 v[92:95], v158, s[40:43], s57 offen offset:1024 sc0 sc1
buffer_load_dwordx4 v[96:99], v158, s[40:43], s57 offen offset:2048 sc0 sc1
buffer_load_dwordx4 v[100:103], v158, s[40:43], s57 offen offset:3072 sc0 sc1
s_sub_u32 s15, s15, 16
s_cbranch_scc0 Lapc_55
s_waitcnt vmcnt(0)
Lapo_56:
ds_write_b64 v148, v[88:89] offset:0
ds_write_b32 v151, v90 offset:32
ds_write_b64 v148, v[92:93] offset:48
ds_write_b32 v151, v94 offset:80
ds_write_b64 v148, v[96:97] offset:96
ds_write_b32 v151, v98 offset:128
ds_write_b64 v148, v[100:101] offset:144
ds_write_b32 v151, v102 offset:176
s_mov_b64 exec, 1
ds_add_u32 v154, v157 offset:136
s_mov_b64 exec, -1
s_mov_b32 s54, 0
Lpoll_57:
ds_read_b32 v165, v154 offset:136
s_waitcnt lgkmcnt(0)
v_readfirstlane_b32 s47, v165
s_sub_u32 s15, s15, 1
s_cselect_b32 s47, 2, s47
s_cmp_lt_u32 s47, 2
s_cbranch_scc1 Lpoll_57
ds_read_b128 v[16:19], v149 offset:0
ds_read_b128 v[20:23], v149 offset:32
ds_read_b128 v[24:27], v149 offset:64
ds_read_b128 v[28:31], v149 offset:96
ds_read_b128 v[32:35], v149 offset:128
ds_read_b128 v[36:39], v149 offset:160
s_mov_b64 exec, 1
ds_add_u32 v156, v157 offset:96
s_mov_b64 exec, -1
s_waitcnt lgkmcnt(6)
v_mfma_f32_32x32x16_bf16 v[104:119], v[16:19], v[16:19], 0
s_waitcnt lgkmcnt(5)
v_mfma_f32_32x32x16_bf16 v[104:119], v[20:23], v[20:23], v[104:119]
s_waitcnt lgkmcnt(4)
v_mfma_f32_32x32x16_bf16 v[104:119], v[24:27], v[24:27], v[104:119]
s_waitcnt lgkmcnt(3)
v_mfma_f32_32x32x16_bf16 v[104:119], v[28:31], v[28:31], v[104:119]
s_waitcnt lgkmcnt(2)
v_mfma_f32_32x32x16_bf16 v[104:119], v[32:35], v[32:35], v[104:119]
s_waitcnt lgkmcnt(1)
v_mfma_f32_32x32x16_bf16 v[104:119], v[36:39], v[36:39], v[104:119]
s_mov_b32 s35, 0x424f9cca
s_setprio 2
s_branch Lw_68e
Lw_68:
s_sleep 3
Lw_68e:
ds_read_b32 v1, v3 offset:0
s_waitcnt lgkmcnt(0)
v_cmp_le_i32 vcc, 2, v1
s_sub_u32 s15, s15, 1
s_cselect_b32 vcc_lo, -1, vcc_lo
s_bitcmp0_b32 vcc_lo, s54
s_cbranch_scc1 Lw_68
ds_read_b128 v[120:123], v4 offset:0
ds_read_b128 v[124:127], v5 offset:0
ds_read_b128 v[128:131], v4 offset:1024
ds_read_b128 v[132:135], v5 offset:1024
ds_read_b128 v[136:139], v4 offset:2048
ds_read_b128 v[140:143], v5 offset:2048
ds_read_b32 v1, v3 offset:0
s_add_u32 s54, s54, 1
s_waitcnt lgkmcnt(6)
v_mfma_f32_32x32x16_bf16 v[88:103], v[120:123], v[16:19], 0
ds_read_b64_tr_b16 v[144:145], v6 offset:0
ds_read_b64_tr_b16 v[146:147], v7 offset:0
s_waitcnt lgkmcnt(7)
v_mfma_f32_32x32x16_bf16 v[88:103], v[124:127], v[20:23], v[88:103]
ds_read_b64_tr_b16 v[148:149], v6 offset:1024
ds_read_b64_tr_b16 v[150:151], v7 offset:1024
s_waitcnt lgkmcnt(8)
v_mfma_f32_32x32x16_bf16 v[88:103], v[128:131], v[24:27], v[88:103]
ds_read_b64_tr_b16 v[152:153], v6 offset:2048
ds_read_b64_tr_b16 v[154:155], v7 offset:2048
s_waitcnt lgkmcnt(9)
v_mfma_f32_32x32x16_bf16 v[88:103], v[132:135], v[28:31], v[88:103]
ds_read_b64_tr_b16 v[156:157], v6 offset:6144
ds_read_b64_tr_b16 v[158:159], v7 offset:6144
s_waitcnt lgkmcnt(10)
v_mfma_f32_32x32x16_bf16 v[88:103], v[136:139], v[32:35], v[88:103]
ds_read_b64_tr_b16 v[160:161], v6 offset:7168
ds_read_b64_tr_b16 v[162:163], v7 offset:7168
s_waitcnt lgkmcnt(11)
v_mfma_f32_32x32x16_bf16 v[88:103], v[140:143], v[36:39], v[88:103]
ds_read_b64_tr_b16 v[164:165], v6 offset:8192
ds_read_b64_tr_b16 v[166:167], v7 offset:8192
s_waitcnt lgkmcnt(12)
v_cmp_le_i32 vcc, 2, v1
ds_read_b128 v[120:123], v4 offset:3072
ds_read_b128 v[124:127], v5 offset:3072
ds_read_b128 v[128:131], v4 offset:4096
ds_read_b128 v[132:135], v5 offset:4096
ds_read_b128 v[136:139], v4 offset:5120
ds_read_b128 v[140:143], v5 offset:5120
v_max3_f32 v104, v104, v105, v106
v_max3_f32 v105, v107, v108, v109
v_max3_f32 v106, v110, v111, v112
v_max3_f32 v107, v113, v114, v115
v_max3_f32 v108, v116, v117, v118
v_max3_f32 v104, v104, v105, v106
v_max3_f32 v107, v107, v108, v119
v_max_f32 v104, v104, v107
v_cmp_nge_f32 s[24:25], s35, v104
s_nop 0
s_cmp_lg_u64 s[24:25], 0
s_cbranch_scc1 Lslow_60
s_bitcmp0_b32 vcc_lo, s54
s_cbranch_scc1 Ldd_64
s_waitcnt lgkmcnt(0)
s_branch Lf_62
Lf_62:
ds_read_b32 v1, v3 offset:0
s_add_u32 s54, s54, 1
s_cmp_eq_u32 s54, 8
s_cselect_b32 s62, s63, s62
v_add_u32 v4, s62, v4
v_add_u32 v5, s62, v5
s_waitcnt lgkmcnt(9)
v_mfma_f32_32x32x16_bf16 v[104:119], v[120:123], v[16:19], 0
v_exp_f32 v88, v88
v_exp_f32 v89, v89
v_exp_f32 v90, v90
v_mfma_f32_32x32x16_bf16 v[104:119], v[124:127], v[20:23], v[104:119]
v_exp_f32 v91, v91
v_exp_f32 v92, v92
v_exp_f32 v93, v93
v_mfma_f32_32x32x16_bf16 v[104:119], v[128:131], v[24:27], v[104:119]
v_exp_f32 v94, v94
v_exp_f32 v95, v95
v_cvt_pk_bf16_f32 v88, v88, v89
v_cvt_pk_bf16_f32 v89, v90, v91
v_mfma_f32_32x32x16_bf16 v[104:119], v[132:135], v[28:31], v[104:119]
v_cvt_pk_bf16_f32 v90, v92, v93
v_cvt_pk_bf16_f32 v91, v94, v95
v_exp_f32 v96, v96
v_exp_f32 v97, v97
v_mfma_f32_32x32x16_bf16 v[104:119], v[136:139], v[32:35], v[104:119]
v_exp_f32 v98, v98
v_exp_f32 v99, v99
v_exp_f32 v100, v100
v_mfma_f32_32x32x16_bf16 v[104:119], v[140:143], v[36:39], v[104:119]
v_exp_f32 v101, v101
v_exp_f32 v102, v102
v_exp_f32 v103, v103
s_waitcnt lgkmcnt(0)
v_mfma_f32_32x32x16_bf16 v[40:55], v[144:147], v[88:91], v[40:55]
v_cvt_pk_bf16_f32 v96, v96, v97
v_cvt_pk_bf16_f32 v97, v98, v99
ds_read_b128 v[120:123], v4 offset:0
ds_read_b128 v[124:127], v5 offset:0
ds_read_b64_tr_b16 v[144:145], v6 offset:3072
ds_read_b64_tr_b16 v[146:147], v7 offset:3072
v_mfma_f32_32x32x16_bf16 v[56:71], v[148:151], v[88:91], v[56:71]
v_cvt_pk_bf16_f32 v98, v100, v101
v_cvt_pk_bf16_f32 v99, v102, v103
ds_read_b128 v[128:131], v4 offset:1024
ds_read_b128 v[132:135], v5 offset:1024
ds_read_b64_tr_b16 v[148:149], v6 offset:4096
ds_read_b64_tr_b16 v[150:151], v7 offset:4096
v_mfma_f32_32x32x16_bf16 v[72:87], v[152:155], v[88:91], v[72:87]
ds_read_b128 v[136:139], v4 offset:2048
ds_read_b128 v[140:143], v5 offset:2048
ds_read_b64_tr_b16 v[152:153], v6 offset:5120
ds_read_b64_tr_b16 v[154:155], v7 offset:5120
v_cmp_le_i32 vcc, 2, v1
v_mfma_f32_32x32x16_bf16 v[40:55], v[156:159], v[96:99], v[40:55]
ds_read_b64_tr_b16 v[156:157], v6 offset:9216
ds_read_b64_tr_b16 v[158:159], v7 offset:9216
v_mfma_f32_32x32x16_bf16 v[56:71], v[160:163], v[96:99], v[56:71]
ds_read_b64_tr_b16 v[160:161], v6 offset:10240
ds_read_b64_tr_b16 v[162:163], v7 offset:10240
v_mfma_f32_32x32x16_bf16 v[72:87], v[164:167], v[96:99], v[72:87]
ds_read_b64_tr_b16 v[164:165], v6 offset:11264
ds_read_b64_tr_b16 v[166:167], v7 offset:11264
v_add_u32 v6, s62, v6
v_add_u32 v7, s62, v7
v_mfma_f32_16x16x32_bf16 v[12:15], v[8:11], v[88:91], v[12:15]
v_mfma_f32_16x16x32_bf16 v[12:15], v[8:11], v[96:99], v[12:15]
s_bitcmp0_b32 vcc_lo, s54
s_cbranch_scc1 Ldd_65
Lf_63:
s_cmp_eq_u32 s54, 8
s_cbranch_scc1 Llast_67
ds_read_b32 v1, v3 offset:0
s_add_u32 s54, s54, 1
s_waitcnt lgkmcnt(9)
v_mfma_f32_32x32x16_bf16 v[88:103], v[120:123], v[16:19], 0
v_exp_f32 v104, v104
v_exp_f32 v105, v105
v_exp_f32 v106, v106
v_mfma_f32_32x32x16_bf16 v[88:103], v[124:127], v[20:23], v[88:103]
v_exp_f32 v107, v107
v_exp_f32 v108, v108
v_exp_f32 v109, v109
v_mfma_f32_32x32x16_bf16 v[88:103], v[128:131], v[24:27], v[88:103]
v_exp_f32 v110, v110
v_exp_f32 v111, v111
v_cvt_pk_bf16_f32 v104, v104, v105
v_cvt_pk_bf16_f32 v105, v106, v107
v_mfma_f32_32x32x16_bf16 v[88:103], v[132:135], v[28:31], v[88:103]
v_cvt_pk_bf16_f32 v106, v108, v109
v_cvt_pk_bf16_f32 v107, v110, v111
v_exp_f32 v112, v112
v_exp_f32 v113, v113
v_mfma_f32_32x32x16_bf16 v[88:103], v[136:139], v[32:35], v[88:103]
v_exp_f32 v114, v114
v_exp_f32 v115, v115
v_exp_f32 v116, v116
v_mfma_f32_32x32x16_bf16 v[88:103], v[140:143], v[36:39], v[88:103]
v_exp_f32 v117, v117
v_exp_f32 v118, v118
v_exp_f32 v119, v119
s_waitcnt lgkmcnt(0)
v_mfma_f32_32x32x16_bf16 v[40:55], v[144:147], v[104:107], v[40:55]
v_cvt_pk_bf16_f32 v112, v112, v113
v_cvt_pk_bf16_f32 v113, v114, v115
ds_read_b128 v[120:123], v4 offset:3072
ds_read_b128 v[124:127], v5 offset:3072
ds_read_b64_tr_b16 v[144:145], v6 offset:0
ds_read_b64_tr_b16 v[146:147], v7 offset:0
v_mfma_f32_32x32x16_bf16 v[56:71], v[148:151], v[104:107], v[56:71]
v_cvt_pk_bf16_f32 v114, v116, v117
v_cvt_pk_bf16_f32 v115, v118, v119
ds_read_b128 v[128:131], v4 offset:4096
ds_read_b128 v[132:135], v5 offset:4096
ds_read_b64_tr_b16 v[148:149], v6 offset:1024
ds_read_b64_tr_b16 v[150:151], v7 offset:1024
v_mfma_f32_32x32x16_bf16 v[72:87], v[152:155], v[104:107], v[72:87]
ds_read_b128 v[136:139], v4 offset:5120
ds_read_b128 v[140:143], v5 offset:5120
ds_read_b64_tr_b16 v[152:153], v6 offset:2048
ds_read_b64_tr_b16 v[154:155], v7 offset:2048
v_cmp_le_i32 vcc, 2, v1
v_mfma_f32_32x32x16_bf16 v[40:55], v[156:159], v[112:115], v[40:55]
ds_read_b64_tr_b16 v[156:157], v6 offset:6144
ds_read_b64_tr_b16 v[158:159], v7 offset:6144
v_mfma_f32_32x32x16_bf16 v[56:71], v[160:163], v[112:115], v[56:71]
ds_read_b64_tr_b16 v[160:161], v6 offset:7168
ds_read_b64_tr_b16 v[162:163], v7 offset:7168
v_mfma_f32_32x32x16_bf16 v[72:87], v[164:167], v[112:115], v[72:87]
ds_read_b64_tr_b16 v[164:165], v6 offset:8192
ds_read_b64_tr_b16 v[166:167], v7 offset:8192
v_mfma_f32_16x16x32_bf16 v[12:15], v[8:11], v[104:107], v[12:15]
v_mfma_f32_16x16x32_bf16 v[12:15], v[8:11], v[112:115], v[12:15]
s_bitcmp0_b32 vcc_lo, s54
s_cbranch_scc1 Ldd_64
s_branch Lf_62
Ldd_64:
s_cmp_eq_u32 s54, 9
s_cbranch_scc1 Lfinal_66
v_exp_f32 v88, v88
v_exp_f32 v89, v89
v_exp_f32 v90, v90
v_exp_f32 v91, v91
v_exp_f32 v92, v92
v_exp_f32 v93, v93
v_exp_f32 v94, v94
v_exp_f32 v95, v95
v_cvt_pk_bf16_f32 v88, v88, v89
v_cvt_pk_bf16_f32 v89, v90, v91
v_cvt_pk_bf16_f32 v90, v92, v93
v_cvt_pk_bf16_f32 v91, v94, v95
v_exp_f32 v96, v96
v_exp_f32 v97, v97
s_waitcnt lgkmcnt(0)
v_mfma_f32_32x32x16_bf16 v[40:55], v[144:147], v[88:91], v[40:55]
v_exp_f32 v98, v98
v_exp_f32 v99, v99
v_exp_f32 v100, v100
v_mfma_f32_32x32x16_bf16 v[56:71], v[148:151], v[88:91], v[56:71]
v_exp_f32 v101, v101
v_exp_f32 v102, v102
v_exp_f32 v103, v103
v_mfma_f32_32x32x16_bf16 v[72:87], v[152:155], v[88:91], v[72:87]
v_cvt_pk_bf16_f32 v96, v96, v97
v_cvt_pk_bf16_f32 v97, v98, v99
v_cvt_pk_bf16_f32 v98, v100, v101
v_cvt_pk_bf16_f32 v99, v102, v103
v_mfma_f32_16x16x32_bf16 v[12:15], v[8:11], v[88:91], v[12:15]
s_nop 0
v_mfma_f32_32x32x16_bf16 v[40:55], v[156:159], v[96:99], v[40:55]
v_mfma_f32_32x32x16_bf16 v[56:71], v[160:163], v[96:99], v[56:71]
v_mfma_f32_32x32x16_bf16 v[72:87], v[164:167], v[96:99], v[72:87]
v_mfma_f32_16x16x32_bf16 v[12:15], v[8:11], v[96:99], v[12:15]
s_branch Lw_69e
Lw_69:
s_sleep 3
Lw_69e:
ds_read_b32 v1, v3 offset:0
s_waitcnt lgkmcnt(0)
v_cmp_le_i32 vcc, 2, v1
s_sub_u32 s15, s15, 1
s_cselect_b32 vcc_lo, -1, vcc_lo
s_bitcmp0_b32 vcc_lo, s54
s_cbranch_scc1 Lw_69
ds_read_b128 v[120:123], v4 offset:3072
ds_read_b128 v[124:127], v5 offset:3072
ds_read_b128 v[128:131], v4 offset:4096
ds_read_b128 v[132:135], v5 offset:4096
ds_read_b128 v[136:139], v4 offset:5120
ds_read_b128 v[140:143], v5 offset:5120
ds_read_b32 v1, v3 offset:0
s_add_u32 s54, s54, 1
s_cmp_eq_u32 s54, 8
s_cselect_b32 s62, s63, s62
v_add_u32 v4, s62, v4
v_add_u32 v5, s62, v5
s_waitcnt lgkmcnt(6)
v_mfma_f32_32x32x16_bf16 v[104:119], v[120:123], v[16:19], 0
ds_read_b64_tr_b16 v[144:145], v6 offset:3072
ds_read_b64_tr_b16 v[146:147], v7 offset:3072
s_waitcnt lgkmcnt(7)
v_mfma_f32_32x32x16_bf16 v[104:119], v[124:127], v[20:23], v[104:119]
ds_read_b64_tr_b16 v[148:149], v6 offset:4096
ds_read_b64_tr_b16 v[150:151], v7 offset:4096
s_waitcnt lgkmcnt(8)
v_mfma_f32_32x32x16_bf16 v[104:119], v[128:131], v[24:27], v[104:119]
ds_read_b64_tr_b16 v[152:153], v6 offset:5120
ds_read_b64_tr_b16 v[154:155], v7 offset:5120
s_waitcnt lgkmcnt(9)
v_mfma_f32_32x32x16_bf16 v[104:119], v[132:135], v[28:31], v[104:119]
ds_read_b64_tr_b16 v[156:157], v6 offset:9216
ds_read_b64_tr_b16 v[158:159], v7 offset:9216
s_waitcnt lgkmcnt(10)
v_mfma_f32_32x32x16_bf16 v[104:119], v[136:139], v[32:35], v[104:119]
ds_read_b64_tr_b16 v[160:161], v6 offset:10240
ds_read_b64_tr_b16 v[162:163], v7 offset:10240
s_waitcnt lgkmcnt(11)
v_mfma_f32_32x32x16_bf16 v[104:119], v[140:143], v[36:39], v[104:119]
ds_read_b64_tr_b16 v[164:165], v6 offset:11264
ds_read_b64_tr_b16 v[166:167], v7 offset:11264
v_add_u32 v6, s62, v6
v_add_u32 v7, s62, v7
s_waitcnt lgkmcnt(12)
v_cmp_le_i32 vcc, 2, v1
ds_read_b128 v[120:123], v4 offset:0
ds_read_b128 v[124:127], v5 offset:0
ds_read_b128 v[128:131], v4 offset:1024
ds_read_b128 v[132:135], v5 offset:1024
ds_read_b128 v[136:139], v4 offset:2048
ds_read_b128 v[140:143], v5 offset:2048
s_bitcmp0_b32 vcc_lo, s54
s_cbranch_scc1 Ldd_65
s_waitcnt lgkmcnt(0)
s_branch Lf_63
Ldd_65:
v_exp_f32 v104, v104
v_exp_f32 v105, v105
v_exp_f32 v106, v106
v_exp_f32 v107, v107
v_exp_f32 v108, v108
v_exp_f32 v109, v109
v_exp_f32 v110, v110
v_exp_f32 v111, v111
v_cvt_pk_bf16_f32 v104, v104, v105
v_cvt_pk_bf16_f32 v105, v106, v107
v_cvt_pk_bf16_f32 v106, v108, v109
v_cvt_pk_bf16_f32 v107, v110, v111
v_exp_f32 v112, v112
v_exp_f32 v113, v113
s_waitcnt lgkmcnt(0)
v_mfma_f32_32x32x16_bf16 v[40:55], v[144:147], v[104:107], v[40:55]
v_exp_f32 v114, v114
v_exp_f32 v115, v115
v_exp_f32 v116, v116
v_mfma_f32_32x32x16_bf16 v[56:71], v[148:151], v[104:107], v[56:71]
v_exp_f32 v117, v117
v_exp_f32 v118, v118
v_exp_f32 v119, v119
v_mfma_f32_32x32x16_bf16 v[72:87], v[152:155], v[104:107], v[72:87]
v_cvt_pk_bf16_f32 v112, v112, v113
v_cvt_pk_bf16_f32 v113, v114, v115
v_cvt_pk_bf16_f32 v114, v116, v117
v_cvt_pk_bf16_f32 v115, v118, v119
v_mfma_f32_16x16x32_bf16 v[12:15], v[8:11], v[104:107], v[12:15]
s_nop 0
v_mfma_f32_32x32x16_bf16 v[40:55], v[156:159], v[112:115], v[40:55]
v_mfma_f32_32x32x16_bf16 v[56:71], v[160:163], v[112:115], v[56:71]
v_mfma_f32_32x32x16_bf16 v[72:87], v[164:167], v[112:115], v[72:87]
v_mfma_f32_16x16x32_bf16 v[12:15], v[8:11], v[112:115], v[12:15]
s_branch Lw_70e
Lw_70:
s_sleep 3
Lw_70e:
ds_read_b32 v1, v3 offset:0
s_waitcnt lgkmcnt(0)
v_cmp_le_i32 vcc, 2, v1
s_sub_u32 s15, s15, 1
s_cselect_b32 vcc_lo, -1, vcc_lo
s_bitcmp0_b32 vcc_lo, s54
s_cbranch_scc1 Lw_70
ds_read_b128 v[120:123], v4 offset:0
ds_read_b128 v[124:127], v5 offset:0
ds_read_b128 v[128:131], v4 offset:1024
ds_read_b128 v[132:135], v5 offset:1024
ds_read_b128 v[136:139], v4 offset:2048
ds_read_b128 v[140:143], v5 offset:2048
ds_read_b32 v1, v3 offset:0
s_add_u32 s54, s54, 1
s_waitcnt lgkmcnt(6)
v_mfma_f32_32x32x16_bf16 v[88:103], v[120:123], v[16:19], 0
ds_read_b64_tr_b16 v[144:145], v6 offset:0
ds_read_b64_tr_b16 v[146:147], v7 offset:0
s_waitcnt lgkmcnt(7)
v_mfma_f32_32x32x16_bf16 v[88:103], v[124:127], v[20:23], v[88:103]
ds_read_b64_tr_b16 v[148:149], v6 offset:1024
ds_read_b64_tr_b16 v[150:151], v7 offset:1024
s_waitcnt lgkmcnt(8)
v_mfma_f32_32x32x16_bf16 v[88:103], v[128:131], v[24:27], v[88:103]
ds_read_b64_tr_b16 v[152:153], v6 offset:2048
ds_read_b64_tr_b16 v[154:155], v7 offset:2048
s_waitcnt lgkmcnt(9)
v_mfma_f32_32x32x16_bf16 v[88:103], v[132:135], v[28:31], v[88:103]
ds_read_b64_tr_b16 v[156:157], v6 offset:6144
ds_read_b64_tr_b16 v[158:159], v7 offset:6144
s_waitcnt lgkmcnt(10)
v_mfma_f32_32x32x16_bf16 v[88:103], v[136:139], v[32:35], v[88:103]
ds_read_b64_tr_b16 v[160:161], v6 offset:7168
ds_read_b64_tr_b16 v[162:163], v7 offset:7168
s_waitcnt lgkmcnt(11)
v_mfma_f32_32x32x16_bf16 v[88:103], v[140:143], v[36:39], v[88:103]
ds_read_b64_tr_b16 v[164:165], v6 offset:8192
ds_read_b64_tr_b16 v[166:167], v7 offset:8192
s_waitcnt lgkmcnt(12)
v_cmp_le_i32 vcc, 2, v1
ds_read_b128 v[120:123], v4 offset:3072
ds_read_b128 v[124:127], v5 offset:3072
ds_read_b128 v[128:131], v4 offset:4096
ds_read_b128 v[132:135], v5 offset:4096
ds_read_b128 v[136:139], v4 offset:5120
ds_read_b128 v[140:143], v5 offset:5120
s_bitcmp0_b32 vcc_lo, s54
s_cbranch_scc1 Ldd_64
s_waitcnt lgkmcnt(0)
s_branch Lf_62
Lfinal_66:
v_mov_b32 v105, 156944
v_add_u32 v106, 4624, v2
v_cndmask_b32 v104, v105, v2, s[18:19]
v_cndmask_b32 v106, v106, v105, s[18:19]
v_mov_b32 v4, 156688
v_mov_b32 v5, 1
s_bitcmp1_b32 vcc_lo, 10
s_cbranch_scc1 L_71
Lpoll_72:
ds_read_b32 v107, v4 offset:80
s_waitcnt lgkmcnt(0)
v_readfirstlane_b32 s47, v107
s_sub_u32 s15, s15, 1
s_cselect_b32 s47, 2, s47
s_cmp_lt_i32 s47, 2
s_cbranch_scc1 Lpoll_72
L_71:
v_mbcnt_lo_u32_b32 v1, -1, 0
v_mbcnt_hi_u32_b32 v1, -1, v1
v_mov_b32 v118, 0
v_exp_f32 v88, v88
v_exp_f32 v89, v89
v_exp_f32 v90, v90
v_exp_f32 v91, v91
v_exp_f32 v92, v92
v_exp_f32 v93, v93
v_exp_f32 v94, v94
v_exp_f32 v95, v95
v_cvt_pk_bf16_f32 v88, v88, v89
v_cvt_pk_bf16_f32 v89, v90, v91
v_cvt_pk_bf16_f32 v90, v92, v93
v_cvt_pk_bf16_f32 v91, v94, v95
v_exp_f32 v96, v96
v_exp_f32 v97, v97
s_waitcnt lgkmcnt(0)
ds_read_b64_tr_b16 v[120:121], v104 offset:0
ds_read_b64_tr_b16 v[122:123], v104 offset:384
ds_read_b64_tr_b16 v[124:125], v0 offset:0
ds_read_b64_tr_b16 v[126:127], v0 offset:384
ds_read_b64_tr_b16 v[128:129], v106 offset:0
ds_read_b64_tr_b16 v[130:131], v106 offset:384
v_mfma_f32_32x32x16_bf16 v[40:55], v[144:147], v[88:91], v[40:55]
v_exp_f32 v98, v98
v_exp_f32 v99, v99
v_exp_f32 v100, v100
v_mfma_f32_32x32x16_bf16 v[56:71], v[148:151], v[88:91], v[56:71]
v_exp_f32 v101, v101
v_exp_f32 v102, v102
v_exp_f32 v103, v103
v_mfma_f32_32x32x16_bf16 v[72:87], v[152:155], v[88:91], v[72:87]
ds_read_b64_tr_b16 v[132:133], v104 offset:768
ds_read_b64_tr_b16 v[134:135], v104 offset:1152
ds_read_b64_tr_b16 v[136:137], v0 offset:768
ds_read_b64_tr_b16 v[138:139], v0 offset:1152
ds_read_b64_tr_b16 v[140:141], v106 offset:768
ds_read_b64_tr_b16 v[142:143], v106 offset:1152
ds_read_b64_tr_b16 v[16:17], v104 offset:1536
ds_read_b64_tr_b16 v[18:19], v104 offset:1920
ds_read_b64_tr_b16 v[20:21], v0 offset:1536
ds_read_b64_tr_b16 v[22:23], v0 offset:1920
ds_read_b64_tr_b16 v[24:25], v106 offset:1536
ds_read_b64_tr_b16 v[26:27], v106 offset:1920
ds_read_b64_tr_b16 v[144:145], v104 offset:3072
ds_read_b64_tr_b16 v[146:147], v104 offset:3456
ds_read_b64_tr_b16 v[148:149], v0 offset:3072
ds_read_b64_tr_b16 v[150:151], v0 offset:3456
ds_read_b64_tr_b16 v[152:153], v106 offset:3072
ds_read_b64_tr_b16 v[154:155], v106 offset:3456
v_cvt_pk_bf16_f32 v96, v96, v97
v_cvt_pk_bf16_f32 v97, v98, v99
v_cvt_pk_bf16_f32 v98, v100, v101
v_cvt_pk_bf16_f32 v99, v102, v103
s_nop 1
v_mfma_f32_32x32x16_bf16 v[40:55], v[156:159], v[96:99], v[40:55]
v_mfma_f32_32x32x16_bf16 v[56:71], v[160:163], v[96:99], v[56:71]
v_mfma_f32_32x32x16_bf16 v[72:87], v[164:167], v[96:99], v[72:87]
ds_read_b64_tr_b16 v[28:29], v104 offset:2304
ds_read_b64_tr_b16 v[30:31], v104 offset:2688
ds_read_b64_tr_b16 v[32:33], v0 offset:2304
ds_read_b64_tr_b16 v[34:35], v0 offset:2688
ds_read_b64_tr_b16 v[36:37], v106 offset:2304
ds_read_b64_tr_b16 v[38:39], v106 offset:2688
ds_read_b64_tr_b16 v[156:157], v104 offset:3840
ds_read_b64_tr_b16 v[158:159], v104 offset:4224
ds_read_b64_tr_b16 v[160:161], v0 offset:3840
ds_read_b64_tr_b16 v[162:163], v0 offset:4224
ds_read_b64_tr_b16 v[164:165], v106 offset:3840
ds_read_b64_tr_b16 v[166:167], v106 offset:4224
v_mfma_f32_16x16x32_bf16 v[12:15], v[8:11], v[88:91], v[12:15]
v_mfma_f32_16x16x32_bf16 v[12:15], v[8:11], v[96:99], v[12:15]
s_branch Lepi_61
Llast_67:
s_waitcnt lgkmcnt(8)
v_mfma_f32_32x32x16_bf16 v[88:103], v[120:123], v[16:19], 0
v_exp_f32 v104, v104
v_exp_f32 v105, v105
v_exp_f32 v106, v106
v_mfma_f32_32x32x16_bf16 v[88:103], v[124:127], v[20:23], v[88:103]
v_exp_f32 v107, v107
v_exp_f32 v108, v108
v_exp_f32 v109, v109
v_mfma_f32_32x32x16_bf16 v[88:103], v[128:131], v[24:27], v[88:103]
v_exp_f32 v110, v110
v_exp_f32 v111, v111
v_cvt_pk_bf16_f32 v104, v104, v105
v_cvt_pk_bf16_f32 v105, v106, v107
v_mfma_f32_32x32x16_bf16 v[88:103], v[132:135], v[28:31], v[88:103]
v_cvt_pk_bf16_f32 v106, v108, v109
v_cvt_pk_bf16_f32 v107, v110, v111
v_exp_f32 v112, v112
v_exp_f32 v113, v113
v_mfma_f32_32x32x16_bf16 v[88:103], v[136:139], v[32:35], v[88:103]
v_exp_f32 v114, v114
v_exp_f32 v115, v115
v_exp_f32 v116, v116
v_mfma_f32_32x32x16_bf16 v[88:103], v[140:143], v[36:39], v[88:103]
v_exp_f32 v117, v117
v_exp_f32 v118, v118
v_exp_f32 v119, v119
s_waitcnt lgkmcnt(0)
v_mfma_f32_32x32x16_bf16 v[40:55], v[144:147], v[104:107], v[40:55]
v_cvt_pk_bf16_f32 v112, v112, v113
v_cvt_pk_bf16_f32 v113, v114, v115
ds_read_b64_tr_b16 v[144:145], v6 offset:0
ds_read_b64_tr_b16 v[146:147], v7 offset:0
v_mfma_f32_32x32x16_bf16 v[56:71], v[148:151], v[104:107], v[56:71]
v_cvt_pk_bf16_f32 v114, v116, v117
v_cvt_pk_bf16_f32 v115, v118, v119
ds_read_b64_tr_b16 v[148:149], v6 offset:1024
ds_read_b64_tr_b16 v[150:151], v7 offset:1024
v_mfma_f32_32x32x16_bf16 v[72:87], v[152:155], v[104:107], v[72:87]
ds_read_b64_tr_b16 v[152:153], v6 offset:2048
ds_read_b64_tr_b16 v[154:155], v7 offset:2048
v_exp_f32 v88, v88
v_exp_f32 v89, v89
v_mfma_f32_32x32x16_bf16 v[40:55], v[156:159], v[112:115], v[40:55]
ds_read_b64_tr_b16 v[156:157], v6 offset:6144
ds_read_b64_tr_b16 v[158:159], v7 offset:6144
v_exp_f32 v90, v90
v_exp_f32 v91, v91
v_exp_f32 v92, v92
v_mfma_f32_32x32x16_bf16 v[56:71], v[160:163], v[112:115], v[56:71]
ds_read_b64_tr_b16 v[160:161], v6 offset:7168
ds_read_b64_tr_b16 v[162:163], v7 offset:7168
v_exp_f32 v93, v93
v_exp_f32 v94, v94
v_exp_f32 v95, v95
v_mfma_f32_32x32x16_bf16 v[72:87], v[164:167], v[112:115], v[72:87]
ds_read_b64_tr_b16 v[164:165], v6 offset:8192
ds_read_b64_tr_b16 v[166:167], v7 offset:8192
v_cvt_pk_bf16_f32 v88, v88, v89
v_cvt_pk_bf16_f32 v89, v90, v91
v_cvt_pk_bf16_f32 v90, v92, v93
v_cvt_pk_bf16_f32 v91, v94, v95
v_mfma_f32_16x16x32_bf16 v[12:15], v[8:11], v[104:107], v[12:15]
v_exp_f32 v96, v96
v_exp_f32 v97, v97
v_mfma_f32_16x16x32_bf16 v[12:15], v[8:11], v[112:115], v[12:15]
v_exp_f32 v98, v98
v_exp_f32 v99, v99
v_mov_b32 v105, 156944
v_add_u32 v106, 4624, v2
v_cndmask_b32 v104, v105, v2, s[18:19]
v_cndmask_b32 v106, v106, v105, s[18:19]
v_mov_b32 v4, 156688
v_mov_b32 v5, 1
s_bitcmp1_b32 vcc_lo, 10
s_cbranch_scc1 L_75
Lpoll_76:
ds_read_b32 v107, v4 offset:80
s_waitcnt lgkmcnt(0)
v_readfirstlane_b32 s47, v107
s_sub_u32 s15, s15, 1
s_cselect_b32 s47, 2, s47
s_cmp_lt_i32 s47, 2
s_cbranch_scc1 Lpoll_76
L_75:
v_mbcnt_lo_u32_b32 v1, -1, 0
v_mbcnt_hi_u32_b32 v1, -1, v1
v_mov_b32 v118, 0
s_waitcnt lgkmcnt(0)
ds_read_b64_tr_b16 v[120:121], v104 offset:0
ds_read_b64_tr_b16 v[122:123], v104 offset:384
ds_read_b64_tr_b16 v[124:125], v0 offset:0
ds_read_b64_tr_b16 v[126:127], v0 offset:384
ds_read_b64_tr_b16 v[128:129], v106 offset:0
ds_read_b64_tr_b16 v[130:131], v106 offset:384
v_mfma_f32_32x32x16_bf16 v[40:55], v[144:147], v[88:91], v[40:55]
v_exp_f32 v100, v100
v_exp_f32 v101, v101
v_exp_f32 v102, v102
v_mfma_f32_32x32x16_bf16 v[56:71], v[148:151], v[88:91], v[56:71]
v_exp_f32 v103, v103
v_cvt_pk_bf16_f32 v96, v96, v97
v_cvt_pk_bf16_f32 v97, v98, v99
v_cvt_pk_bf16_f32 v98, v100, v101
v_mfma_f32_32x32x16_bf16 v[72:87], v[152:155], v[88:91], v[72:87]
v_cvt_pk_bf16_f32 v99, v102, v103
ds_read_b64_tr_b16 v[132:133], v104 offset:768
ds_read_b64_tr_b16 v[134:135], v104 offset:1152
ds_read_b64_tr_b16 v[136:137], v0 offset:768
ds_read_b64_tr_b16 v[138:139], v0 offset:1152
ds_read_b64_tr_b16 v[140:141], v106 offset:768
ds_read_b64_tr_b16 v[142:143], v106 offset:1152
ds_read_b64_tr_b16 v[16:17], v104 offset:1536
ds_read_b64_tr_b16 v[18:19], v104 offset:1920
ds_read_b64_tr_b16 v[20:21], v0 offset:1536
ds_read_b64_tr_b16 v[22:23], v0 offset:1920
ds_read_b64_tr_b16 v[24:25], v106 offset:1536
ds_read_b64_tr_b16 v[26:27], v106 offset:1920
ds_read_b64_tr_b16 v[144:145], v104 offset:3072
ds_read_b64_tr_b16 v[146:147], v104 offset:3456
ds_read_b64_tr_b16 v[148:149], v0 offset:3072
ds_read_b64_tr_b16 v[150:151], v0 offset:3456
ds_read_b64_tr_b16 v[152:153], v106 offset:3072
ds_read_b64_tr_b16 v[154:155], v106 offset:3456
v_mfma_f32_32x32x16_bf16 v[40:55], v[156:159], v[96:99], v[40:55]
v_mfma_f32_32x32x16_bf16 v[56:71], v[160:163], v[96:99], v[56:71]
v_mfma_f32_32x32x16_bf16 v[72:87], v[164:167], v[96:99], v[72:87]
ds_read_b64_tr_b16 v[28:29], v104 offset:2304
ds_read_b64_tr_b16 v[30:31], v104 offset:2688
ds_read_b64_tr_b16 v[32:33], v0 offset:2304
ds_read_b64_tr_b16 v[34:35], v0 offset:2688
ds_read_b64_tr_b16 v[36:37], v106 offset:2304
ds_read_b64_tr_b16 v[38:39], v106 offset:2688
ds_read_b64_tr_b16 v[156:157], v104 offset:3840
ds_read_b64_tr_b16 v[158:159], v104 offset:4224
ds_read_b64_tr_b16 v[160:161], v0 offset:3840
ds_read_b64_tr_b16 v[162:163], v0 offset:4224
ds_read_b64_tr_b16 v[164:165], v106 offset:3840
ds_read_b64_tr_b16 v[166:167], v106 offset:4224
v_mfma_f32_16x16x32_bf16 v[12:15], v[8:11], v[88:91], v[12:15]
v_mfma_f32_16x16x32_bf16 v[12:15], v[8:11], v[96:99], v[12:15]
Lepi_61:
v_cvt_pk_bf16_f32 v40, v40, v41
v_cvt_pk_bf16_f32 v41, v42, v43
v_cvt_pk_bf16_f32 v42, v44, v45
v_cvt_pk_bf16_f32 v43, v46, v47
s_waitcnt lgkmcnt(0)
s_nop 0
v_mfma_f32_16x16x32_bf16 v[104:107], v[120:123], v[40:43], 0
v_cvt_pk_bf16_f32 v44, v48, v49
v_cvt_pk_bf16_f32 v45, v50, v51
v_mfma_f32_16x16x32_bf16 v[108:111], v[124:127], v[40:43], 0
v_cvt_pk_bf16_f32 v46, v52, v53
s_lshl_b32 s47, s45, 12
v_mfma_f32_16x16x32_bf16 v[112:115], v[128:131], v[40:43], 0
v_cvt_pk_bf16_f32 v47, v54, v55
s_add_u32 s47, s47, 147472
s_nop 0
v_mfma_f32_16x16x32_bf16 v[104:107], v[132:135], v[44:47], v[104:107]
v_cvt_pk_bf16_f32 v48, v56, v57
v_cvt_pk_bf16_f32 v49, v58, v59
v_mfma_f32_16x16x32_bf16 v[108:111], v[136:139], v[44:47], v[108:111]
v_cvt_pk_bf16_f32 v50, v60, v61
v_lshl_add_u32 v6, v1, 4, s47
v_mfma_f32_16x16x32_bf16 v[112:115], v[140:143], v[44:47], v[112:115]
v_cvt_pk_bf16_f32 v51, v62, v63
v_lshl_add_u32 v7, s45, 3, v4
s_nop 0
v_mfma_f32_16x16x32_bf16 v[104:107], v[16:19], v[48:51], v[104:107]
v_cvt_pk_bf16_f32 v52, v64, v65
v_cvt_pk_bf16_f32 v53, v66, v67
v_mfma_f32_16x16x32_bf16 v[108:111], v[20:23], v[48:51], v[108:111]
v_cvt_pk_bf16_f32 v54, v68, v69
v_and_b32 v3, 15, v1
v_mfma_f32_16x16x32_bf16 v[112:115], v[24:27], v[48:51], v[112:115]
v_cvt_pk_bf16_f32 v55, v70, v71
v_lshlrev_b32 v100, 13, v3
s_nop 0
v_mfma_f32_16x16x32_bf16 v[104:107], v[28:31], v[52:55], v[104:107]
v_cvt_pk_bf16_f32 v56, v72, v73
v_cvt_pk_bf16_f32 v57, v74, v75
v_mfma_f32_16x16x32_bf16 v[108:111], v[32:35], v[52:55], v[108:111]
v_cvt_pk_bf16_f32 v58, v76, v77
v_lshlrev_b32 v3, 16, v3
v_mfma_f32_16x16x32_bf16 v[112:115], v[36:39], v[52:55], v[112:115]
v_cvt_pk_bf16_f32 v59, v78, v79
v_lshrrev_b32 v2, 4, v1
s_nop 0
v_mfma_f32_16x16x32_bf16 v[104:107], v[144:147], v[56:59], v[104:107]
v_cvt_pk_bf16_f32 v60, v80, v81
v_cvt_pk_bf16_f32 v61, v82, v83
v_mfma_f32_16x16x32_bf16 v[108:111], v[148:151], v[56:59], v[108:111]
v_cvt_pk_bf16_f32 v62, v84, v85
v_lshl_add_u32 v3, v2, 4, v3
v_mfma_f32_16x16x32_bf16 v[112:115], v[152:155], v[56:59], v[112:115]
v_cvt_pk_bf16_f32 v63, v86, v87
s_lshl_b32 s57, s2, 8
s_nop 0
v_mfma_f32_16x16x32_bf16 v[104:107], v[156:159], v[60:63], v[104:107]
s_lshl_b32 s58, s45, 7
s_add_u32 s57, s57, s58
v_mfma_f32_16x16x32_bf16 v[108:111], v[160:163], v[60:63], v[108:111]
s_lshr_b32 s58, s57, 3
s_add_u32 s58, s58, 1048576
v_mfma_f32_16x16x32_bf16 v[112:115], v[164:167], v[60:63], v[112:115]
v_mov_b32 v91, s14
v_mov_b32 v99, s14
v_mov_b32 v98, v118
s_cmp_eq_u32 s46, 0
s_cbranch_scc1 Lk0_79
ds_write_b128 v6, v[104:107]
ds_write_b64 v6, v[108:109] offset:1024
s_mov_b64 exec, 1
ds_add_u32 v7, v5 offset:108
s_mov_b64 exec, -1
Lpoll_80:
ds_read_b32 v0, v7 offset:104
s_waitcnt lgkmcnt(0)
v_readfirstlane_b32 s47, v0
s_sub_u32 s15, s15, 1
s_cselect_b32 s47, 1, s47
s_cmp_lt_u32 s47, 1
s_cbranch_scc1 Lpoll_80
ds_read_b128 v[144:147], v6 offset:2048
ds_read_b128 v[148:151], v6 offset:3072
s_waitcnt lgkmcnt(1)
v_add_f32 v112, v112, v144
v_add_f32 v113, v113, v145
v_cvt_pk_bf16_f32 v88, v112, v113
v_add_f32 v114, v114, v146
v_add_f32 v115, v115, v147
v_cvt_pk_bf16_f32 v89, v114, v115
s_waitcnt lgkmcnt(0)
v_add_f32 v110, v110, v148
v_add_f32 v111, v111, v149
v_cvt_pk_bf16_f32 v90, v110, v111
buffer_store_dwordx4 v[88:91], v3, s[40:43], s57 offen offset:64 sc0 sc1
s_mov_b64 exec, 0xffff
v_add_f32 v12, v12, v150
v_add_f32 v13, v13, v151
v_and_b32 v156, s9, v12
v_and_b32 v157, s9, v13
v_sub_f32 v12, v12, v156
v_sub_f32 v13, v13, v157
v_cvt_pk_bf16_f32 v96, v156, v12
v_cvt_pk_bf16_f32 v97, v157, v13
buffer_store_dwordx4 v[96:99], v100, s[40:43], s58 offen sc0 sc1
s_mov_b64 exec, 1
ds_add_u32 v4, v5 offset:148
s_mov_b64 exec, -1
s_endpgm
Lk0_79:
s_nop 2
ds_write_b128 v6, v[112:115] offset:2048
ds_write_b64 v6, v[110:111] offset:3072
ds_write_b64 v6, v[12:13] offset:3080
s_mov_b64 exec, 1
ds_add_u32 v7, v5 offset:104
s_mov_b64 exec, -1
Lpoll_83:
ds_read_b32 v0, v7 offset:108
s_waitcnt lgkmcnt(0)
v_readfirstlane_b32 s47, v0
s_sub_u32 s15, s15, 1
s_cselect_b32 s47, 1, s47
s_cmp_lt_u32 s47, 1
s_cbranch_scc1 Lpoll_83
ds_read_b128 v[144:147], v6
ds_read_b64 v[148:149], v6 offset:1024
s_waitcnt lgkmcnt(1)
v_add_f32 v104, v104, v144
v_add_f32 v105, v105, v145
v_cvt_pk_bf16_f32 v88, v104, v105
v_add_f32 v106, v106, v146
v_add_f32 v107, v107, v147
v_cvt_pk_bf16_f32 v89, v106, v107
s_waitcnt lgkmcnt(0)
v_add_f32 v108, v108, v148
v_add_f32 v109, v109, v149
v_cvt_pk_bf16_f32 v90, v108, v109
buffer_store_dwordx4 v[88:91], v3, s[40:43], s57 offen sc0 sc1
s_mov_b64 exec, 1
ds_add_u32 v4, v5 offset:148
s_mov_b64 exec, -1
s_endpgm
Lslow_60:
s_mov_b32 s54, 0
s_waitcnt lgkmcnt(0)
v_mov_b32 v119, 0xff800000
v_mov_b32 v117, v4
v_mov_b32 v118, v5
Ls1_86:
s_branch Lw_88e
Lw_88:
s_sleep 3
Lw_88e:
ds_read_b32 v1, v3 offset:0
s_waitcnt lgkmcnt(0)
v_cmp_le_i32 vcc, 2, v1
s_sub_u32 s15, s15, 1
s_cselect_b32 vcc_lo, -1, vcc_lo
s_bitcmp0_b32 vcc_lo, s54
s_cbranch_scc1 Lw_88
ds_read_b128 v[120:123], v4 offset:0
ds_read_b128 v[124:127], v5 offset:0
ds_read_b128 v[128:131], v4 offset:1024
ds_read_b128 v[132:135], v5 offset:1024
ds_read_b128 v[136:139], v4 offset:2048
ds_read_b128 v[140:143], v5 offset:2048
s_cmp_eq_u32 s54, 7
s_cselect_b32 s62, s63, 24576
s_sub_u32 s62, s62, 3072
s_bitcmp0_b32 s54, 0
s_cselect_b32 s62, 3072, s62
v_add_u32 v4, s62, v4
v_add_u32 v5, s62, v5
s_waitcnt lgkmcnt(5)
v_mfma_f32_32x32x16_bf16 v[88:103], v[120:123], v[16:19], 0
s_waitcnt lgkmcnt(4)
v_mfma_f32_32x32x16_bf16 v[88:103], v[124:127], v[20:23], v[88:103]
s_waitcnt lgkmcnt(3)
v_mfma_f32_32x32x16_bf16 v[88:103], v[128:131], v[24:27], v[88:103]
s_waitcnt lgkmcnt(2)
v_mfma_f32_32x32x16_bf16 v[88:103], v[132:135], v[28:31], v[88:103]
s_waitcnt lgkmcnt(1)
v_mfma_f32_32x32x16_bf16 v[88:103], v[136:139], v[32:35], v[88:103]
s_waitcnt lgkmcnt(0)
v_mfma_f32_32x32x16_bf16 v[88:103], v[140:143], v[36:39], v[88:103]
s_nop 11
v_max3_f32 v119, v88, v89, v119
v_max3_f32 v119, v90, v91, v119
v_max3_f32 v119, v92, v93, v119
v_max3_f32 v119, v94, v95, v119
v_max3_f32 v119, v96, v97, v119
v_max3_f32 v119, v98, v99, v119
v_max3_f32 v119, v100, v101, v119
v_max3_f32 v119, v102, v103, v119
s_add_u32 s54, s54, 1
s_cmp_lt_u32 s54, 9
s_cbranch_scc1 Ls1_86
v_mov_b32 v4, v117
v_mov_b32 v5, v118
v_mov_b32 v112, v119
s_nop 1
v_permlane32_swap_b32 v119, v112
v_max_f32 v119, v119, v112
v_mov_b32 v113, 156688
v_mov_b32 v115, 1
Lpoll_89:
ds_read_b32 v116, v113 offset:96
s_waitcnt lgkmcnt(0)
v_readfirstlane_b32 s47, v116
s_sub_u32 s15, s15, 1
s_cselect_b32 s47, 4, s47
s_cmp_ge_u32 s47, 4
s_cbranch_scc1 Lpd_90
s_sleep 1
s_branch Lpoll_89
Lpd_90:
v_mbcnt_lo_u32_b32 v114, -1, 0
v_mbcnt_hi_u32_b32 v114, -1, v114
v_lshlrev_b32 v114, 2, v114
s_lshl_b32 s47, s44, 8
s_add_u32 s47, s47, 155664
v_add_u32 v112, s47, v114
ds_write_b32 v112, v119
s_lshl_b32 s47, s45, 2
v_add_u32 v113, s47, v113
s_mov_b64 exec, 1
ds_add_u32 v113, v115 offset:192
s_mov_b64 exec, -1
Lpoll_92:
ds_read_b32 v116, v113 offset:192
s_waitcnt lgkmcnt(0)
v_readfirstlane_b32 s47, v116
s_sub_u32 s15, s15, 1
s_cselect_b32 s47, 2, s47
s_cmp_ge_u32 s47, 2
s_cbranch_scc1 Lpd_93
s_sleep 1
s_branch Lpoll_92
Lpd_93:
s_xor_b32 s47, s44, 1
s_lshl_b32 s47, s47, 8
s_add_u32 s47, s47, 155664
v_add_u32 v112, s47, v114
ds_read_b32 v112, v112
s_waitcnt lgkmcnt(0)
v_max_f32 v119, v119, v112
s_mov_b32 s54, 0
v_cvt_pk_bf16_f32 v119, v119, v119
v_and_b32 v119, s9, v119
v_or_b32 v119, 0x10000, v119
Ls2_87:
ds_read_b128 v[120:123], v4 offset:0
ds_read_b128 v[124:127], v5 offset:0
ds_read_b128 v[128:131], v4 offset:1024
ds_read_b128 v[132:135], v5 offset:1024
ds_read_b128 v[136:139], v4 offset:2048
ds_read_b128 v[140:143], v5 offset:2048
s_cmp_eq_u32 s54, 7
s_cselect_b32 s62, s63, 24576
s_sub_u32 s62, s62, 3072
s_bitcmp0_b32 s54, 0
s_cselect_b32 s62, 3072, s62
v_add_u32 v4, s62, v4
v_add_u32 v5, s62, v5
s_waitcnt lgkmcnt(5)
v_mfma_f32_32x32x16_bf16 v[88:103], v[120:123], v[16:19], 0
ds_read_b64_tr_b16 v[144:145], v6 offset:0
ds_read_b64_tr_b16 v[146:147], v7 offset:0
s_waitcnt lgkmcnt(6)
v_mfma_f32_32x32x16_bf16 v[88:103], v[124:127], v[20:23], v[88:103]
ds_read_b64_tr_b16 v[148:149], v6 offset:1024
ds_read_b64_tr_b16 v[150:151], v7 offset:1024
s_waitcnt lgkmcnt(7)
v_mfma_f32_32x32x16_bf16 v[88:103], v[128:131], v[24:27], v[88:103]
ds_read_b64_tr_b16 v[152:153], v6 offset:2048
ds_read_b64_tr_b16 v[154:155], v7 offset:2048
s_waitcnt lgkmcnt(8)
v_mfma_f32_32x32x16_bf16 v[88:103], v[132:135], v[28:31], v[88:103]
ds_read_b64_tr_b16 v[156:157], v6 offset:6144
ds_read_b64_tr_b16 v[158:159], v7 offset:6144
s_waitcnt lgkmcnt(9)
v_mfma_f32_32x32x16_bf16 v[88:103], v[136:139], v[32:35], v[88:103]
ds_read_b64_tr_b16 v[160:161], v6 offset:7168
ds_read_b64_tr_b16 v[162:163], v7 offset:7168
s_waitcnt lgkmcnt(10)
v_mfma_f32_32x32x16_bf16 v[88:103], v[140:143], v[36:39], v[88:103]
ds_read_b64_tr_b16 v[164:165], v6 offset:8192
ds_read_b64_tr_b16 v[166:167], v7 offset:8192
v_add_u32 v6, s62, v6
v_add_u32 v7, s62, v7
s_nop 7
v_sub_f32 v88, v88, v119
v_exp_f32 v88, v88
v_sub_f32 v89, v89, v119
v_exp_f32 v89, v89
v_sub_f32 v90, v90, v119
v_exp_f32 v90, v90
v_sub_f32 v91, v91, v119
v_exp_f32 v91, v91
v_sub_f32 v92, v92, v119
v_exp_f32 v92, v92
v_sub_f32 v93, v93, v119
v_exp_f32 v93, v93
v_sub_f32 v94, v94, v119
v_exp_f32 v94, v94
v_sub_f32 v95, v95, v119
v_exp_f32 v95, v95
v_cvt_pk_bf16_f32 v88, v88, v89
v_cvt_pk_bf16_f32 v89, v90, v91
v_cvt_pk_bf16_f32 v90, v92, v93
v_cvt_pk_bf16_f32 v91, v94, v95
v_sub_f32 v96, v96, v119
v_exp_f32 v96, v96
v_sub_f32 v97, v97, v119
v_exp_f32 v97, v97
s_waitcnt lgkmcnt(0)
v_mfma_f32_32x32x16_bf16 v[40:55], v[144:147], v[88:91], v[40:55]
v_sub_f32 v98, v98, v119
v_exp_f32 v98, v98
v_sub_f32 v99, v99, v119
v_exp_f32 v99, v99
v_sub_f32 v100, v100, v119
v_exp_f32 v100, v100
v_mfma_f32_32x32x16_bf16 v[56:71], v[148:151], v[88:91], v[56:71]
v_sub_f32 v101, v101, v119
v_exp_f32 v101, v101
v_sub_f32 v102, v102, v119
v_exp_f32 v102, v102
v_sub_f32 v103, v103, v119
v_exp_f32 v103, v103
v_mfma_f32_32x32x16_bf16 v[72:87], v[152:155], v[88:91], v[72:87]
v_cvt_pk_bf16_f32 v96, v96, v97
v_cvt_pk_bf16_f32 v97, v98, v99
v_cvt_pk_bf16_f32 v98, v100, v101
v_cvt_pk_bf16_f32 v99, v102, v103
v_mfma_f32_16x16x32_bf16 v[12:15], v[8:11], v[88:91], v[12:15]
s_nop 0
v_mfma_f32_32x32x16_bf16 v[40:55], v[156:159], v[96:99], v[40:55]
v_mfma_f32_32x32x16_bf16 v[56:71], v[160:163], v[96:99], v[56:71]
v_mfma_f32_32x32x16_bf16 v[72:87], v[164:167], v[96:99], v[72:87]
v_mfma_f32_16x16x32_bf16 v[12:15], v[8:11], v[96:99], v[12:15]
s_add_u32 s54, s54, 1
s_cmp_lt_u32 s54, 9
s_cbranch_scc1 Ls2_87
v_mov_b32 v118, v119
s_nop 1
v_permlane16_swap_b32 v118, v119
v_cvt_pk_bf16_f32 v118, v118, v119
v_mov_b32 v105, 156944
v_add_u32 v106, 4624, v2
v_cndmask_b32 v104, v105, v2, s[18:19]
v_cndmask_b32 v106, v106, v105, s[18:19]
v_mov_b32 v4, 156688
v_mov_b32 v5, 1
Lpoll_96:
ds_read_b32 v107, v4 offset:80
s_waitcnt lgkmcnt(0)
v_readfirstlane_b32 s47, v107
s_sub_u32 s15, s15, 1
s_cselect_b32 s47, 2, s47
s_cmp_lt_i32 s47, 2
s_cbranch_scc1 Lpoll_96
L_95:
v_mbcnt_lo_u32_b32 v1, -1, 0
v_mbcnt_hi_u32_b32 v1, -1, v1
ds_read_b64_tr_b16 v[120:121], v104 offset:0
ds_read_b64_tr_b16 v[122:123], v104 offset:384
ds_read_b64_tr_b16 v[124:125], v0 offset:0
ds_read_b64_tr_b16 v[126:127], v0 offset:384
ds_read_b64_tr_b16 v[128:129], v106 offset:0
ds_read_b64_tr_b16 v[130:131], v106 offset:384
ds_read_b64_tr_b16 v[132:133], v104 offset:768
ds_read_b64_tr_b16 v[134:135], v104 offset:1152
ds_read_b64_tr_b16 v[136:137], v0 offset:768
ds_read_b64_tr_b16 v[138:139], v0 offset:1152
ds_read_b64_tr_b16 v[140:141], v106 offset:768
ds_read_b64_tr_b16 v[142:143], v106 offset:1152
ds_read_b64_tr_b16 v[16:17], v104 offset:1536
ds_read_b64_tr_b16 v[18:19], v104 offset:1920
ds_read_b64_tr_b16 v[20:21], v0 offset:1536
ds_read_b64_tr_b16 v[22:23], v0 offset:1920
ds_read_b64_tr_b16 v[24:25], v106 offset:1536
ds_read_b64_tr_b16 v[26:27], v106 offset:1920
ds_read_b64_tr_b16 v[28:29], v104 offset:2304
ds_read_b64_tr_b16 v[30:31], v104 offset:2688
ds_read_b64_tr_b16 v[32:33], v0 offset:2304
ds_read_b64_tr_b16 v[34:35], v0 offset:2688
ds_read_b64_tr_b16 v[36:37], v106 offset:2304
ds_read_b64_tr_b16 v[38:39], v106 offset:2688
ds_read_b64_tr_b16 v[144:145], v104 offset:3072
ds_read_b64_tr_b16 v[146:147], v104 offset:3456
ds_read_b64_tr_b16 v[148:149], v0 offset:3072
ds_read_b64_tr_b16 v[150:151], v0 offset:3456
ds_read_b64_tr_b16 v[152:153], v106 offset:3072
ds_read_b64_tr_b16 v[154:155], v106 offset:3456
ds_read_b64_tr_b16 v[156:157], v104 offset:3840
ds_read_b64_tr_b16 v[158:159], v104 offset:4224
ds_read_b64_tr_b16 v[160:161], v0 offset:3840
ds_read_b64_tr_b16 v[162:163], v0 offset:4224
ds_read_b64_tr_b16 v[164:165], v106 offset:3840
ds_read_b64_tr_b16 v[166:167], v106 offset:4224
s_branch Lepi_61
L_exit:
s_endpgm
.section .rodata,"a"
.p2align 6
.amdhsa_kernel standalone__detection_seg_mask2former__vision_kernel
  .amdhsa_next_free_vgpr 168
  .amdhsa_next_free_sgpr 96
  .amdhsa_accum_offset 168
  .amdhsa_group_segment_fixed_size 0
  .amdhsa_kernarg_size 96
  .amdhsa_user_sgpr_count 2
  .amdhsa_user_sgpr_kernarg_segment_ptr 1
  .amdhsa_system_sgpr_workgroup_id_x 1
  .amdhsa_float_denorm_mode_32 3
.end_amdhsa_kernel
```
